```python
import torch

def _softmax(x, axis=-1):
    return torch.softmax(x, dim=axis)
def _gelu(x):
    return torch.nn.functional.gelu(x, approximate="tanh")
def _silu(x):
    return torch.nn.functional.silu(x)
def _sigmoid(x):
    return torch.sigmoid(x)
def _layernorm(x, axis=-1, eps=1e-5):
    m = x.mean(dim=axis, keepdim=True)
    v = x.var(dim=axis, keepdim=True, unbiased=False)
    return (x - m) / torch.sqrt(v + eps)
def _scatter_add(tgt, idx, src, axis=0):
    return tgt.clone().index_add_(axis, idx, src)
def _segment_sum(src, seg, n):
    out = torch.zeros((n,) + src.shape[1:], dtype=src.dtype)
    return out.index_add_(0, seg, src)
def _pad(x, pw):
    flat = tuple(v for pair in reversed(pw) for v in pair)
    return torch.nn.functional.pad(x, flat)

kernel_name = 'sequential_preLN__ssm_conv_s4__glu_gated_bilinear__prompt'

def setup_inputs():

    _w = (lambda a: (lambda t: t.to(torch.bfloat16) if t.is_floating_point() else t)(torch.as_tensor(a)))
    def _A_setup():
        B, L, D, N = 1, 2048, 640, 128
        A_re = -(lambda _x: torch.exp(torch.as_tensor(_x)))((lambda *s: torch.randn(*s, dtype=torch.bfloat16) * 6.4)(D, N))
        A_im = torch.pi * (lambda *s: torch.randn(*s, dtype=torch.bfloat16) * 0.05)(D, N)
        B_re = (lambda *s: torch.randn(*s, dtype=torch.bfloat16) * 0.05)(D, N)
        B_im = (lambda *s: torch.randn(*s, dtype=torch.bfloat16) * 0.05)(D, N)
        C_re = (lambda *s: torch.randn(*s, dtype=torch.bfloat16) * 0.05)(D, N)
        C_im = (lambda *s: torch.randn(*s, dtype=torch.bfloat16) * 0.05)(D, N)
        log_dt = (lambda *s: torch.randn(*s, dtype=torch.bfloat16) * 0.05)(D) * 0.5 - 4.0
        Dskip = (lambda *s: torch.randn(*s, dtype=torch.bfloat16) * 0.05)(D)
        return {
            "u": _w((lambda *s: torch.randn(*s, dtype=torch.bfloat16) * 0.05)(B, L, D)),
            "A_re": _w(A_re),
            "A_im": _w(A_im),
            "B_re": _w(B_re),
            "B_im": _w(B_im),
            "C_re": _w(C_re),
            "C_im": _w(C_im),
            "log_dt": _w(log_dt),
            "Dskip": _w(Dskip),
        }
    _A_in = _A_setup()

    def _B_setup():
        B, S, D, F = 1, 2048, 640, 1728
        return {
            "x": _w((lambda *s: torch.randn(*s, dtype=torch.bfloat16) * 0.05)(B, S, D)),
            "w_gate": _w((lambda *s: torch.randn(*s, dtype=torch.bfloat16) * 0.4)(D, F) * (D ** -0.5)),
            "w_up": _w((lambda *s: torch.randn(*s, dtype=torch.bfloat16) * 0.4)(D, F) * (D ** -0.5)),
            "w_down": _w((lambda *s: torch.randn(*s, dtype=torch.bfloat16) * 0.4)(F, D) * (F ** -0.5)),
        }
    _B_in = _B_setup()

    return {
        "A_u": _A_in["u"],
        "A_A_re": _A_in["A_re"],
        "A_A_im": _A_in["A_im"],
        "A_B_re": _A_in["B_re"],
        "A_B_im": _A_in["B_im"],
        "A_C_re": _A_in["C_re"],
        "A_C_im": _A_in["C_im"],
        "A_log_dt": _A_in["log_dt"],
        "A_Dskip": _A_in["Dskip"],
        "B_x": _B_in["x"],
        "B_w_gate": _B_in["w_gate"],
        "B_w_up": _B_in["w_up"],
        "B_w_down": _B_in["w_down"],
    }

def reference(A_u, A_A_re, A_A_im, A_B_re, A_B_im, A_C_re, A_C_im, A_log_dt, A_Dskip, B_x, B_w_gate, B_w_up, B_w_down):
    def _A_ref(u, A_re, A_im, B_re, B_im, C_re, C_im, log_dt, Dskip):
        Bsz, L, D = u.shape
        dt = torch.exp(log_dt)[:, None]
        A = A_re + 1j * A_im
        Bc = B_re + 1j * B_im
        Cc = C_re + 1j * C_im
        logdA = dt * A
        dB = dt * Bc
        l = (lambda x, dt: x.to(dt))(torch.arange(L), A_re.dtype)
        P = torch.exp(logdA[:, :, None] * l[None, None, :])
        K = torch.einsum("dn,dnl,dn->dl", Cc, P, dB).real
        L2 = 2 * L
        Kp = _pad(K, ((0, 0), (0, L)))
        up = (lambda x, *d: x.permute(*d))(u, 0, 2, 1)
        up = _pad(up, ((0, 0), (0, 0), (0, L)))
        Kf = (lambda x, axes=(-2,-1): torch.fft.rfft2(x.float(), dim=axes))(Kp[:, None, :], axes=(-2, -1))
        Uf = (lambda x, axes=(-2,-1): torch.fft.rfft2(x.float(), dim=axes))(up[:, :, None, :], axes=(-2, -1))
        Yf = Uf * Kf[None, :, :, :]
        y = (lambda x, s, axes=(-2,-1): torch.fft.irfft2(x, s=s, dim=axes).to(torch.bfloat16))(Yf, (1, L2), axes=(-2, -1))[:, :, 0, :L]
        y = (lambda x, *d: x.permute(*d))(y, 0, 2, 1) + u * Dskip[None, None, :]
        return y

    def _B_ref(x, w_gate, w_up, w_down):
        g = torch.einsum("bsd,df->bsf", x, w_gate)
        u = torch.einsum("bsd,df->bsf", x, w_up)
        h = g * u
        return torch.einsum("bsf,fd->bsd", h, w_down)

    x = A_u
    h = x + _A_ref(_layernorm(x, axis=-1), A_A_re, A_A_im, A_B_re, A_B_im, A_C_re, A_C_im, A_log_dt, A_Dskip)
    h2 = h + _B_ref(_layernorm(h, axis=-1), B_w_gate, B_w_up, B_w_down)
    return h2
```

```asm
; @launch grid=(256,1,1) block=(512,1,1) lds=163840
.amdgcn_target "amdgcn-amd-amdhsa--gfx950"
.text
.globl sequential_preLN__ssm_conv_s4__glu_gated_bilinear__prompt_kernel
.p2align 8
.type sequential_preLN__ssm_conv_s4__glu_gated_bilinear__prompt_kernel,@function
sequential_preLN__ssm_conv_s4__glu_gated_bilinear__prompt_kernel:
    s_cmp_ge_u32 s2, 256
    s_cbranch_scc1 K_END
    s_load_dwordx16 s[16:31], s[0:1], 0
    s_load_dwordx2 s[32:33], s[0:1], 64
    s_load_dwordx4 s[36:39], s[0:1], 80
    s_load_dwordx4 s[92:95], s[0:1], 96
    s_load_dwordx2 s[6:7], s[0:1], 120
    v_lshrrev_b32 v2, 6, v0
    v_and_b32 v1, 63, v0
    v_readfirstlane_b32 s60, v2
    v_and_b32 v0, 255, v0
    s_getpc_b64 s[62:63]
K1_PC:
    s_lshr_b32 s40, s2, 3
    s_and_b32 s40, s40, 7
    s_lshl_b32 s40, s40, 13
    v_lshl_add_u32 v8, v1, 7, s40
    v_min_u32 v8, CODE_END - K1_PC - 4, v8
    s_cmp_lg_u32 s60, 3
    s_cbranch_scc1 K1_NOPF
    s_cmp_lt_u32 s2, 160
    s_cbranch_scc1 K1_NOPF2
    global_load_dword v255, v8, s[62:63]
K1_NOPF2:
    v_mov_b32 v8, 163328
    v_mov_b64 v[10:11], 0
    ds_write_b64 v8, v[10:11]
    ds_write_b64 v8, v[10:11] offset:8
    ds_write_b64 v8, v[10:11] offset:16
K1_NOPF:
    s_and_b32 s4, s60, 3
    s_lshr_b32 s61, s60, 2
    s_and_b32 s40, s2, 7
    s_lshr_b32 s41, s2, 3
    s_mul_i32 s57, s40, 20
    s_add_u32 s57, s57, s41
    s_lshl_b32 s5, s57, 2
    s_add_u32 s5, s5, s4
    s_lshl_b32 s43, s5, 8
    v_lshl_add_u32 v6, v1, 2, s43
    s_lshl_b32 s3, s57, 3
    s_mul_i32 s55, s4, 17408
    v_mul_u32_u24 v238, 10240, v0
    v_add_u32 v238, s3, v238
    s_mul_i32 s46, s41, 103
    v_lshrrev_b32 v2, 1, v0
    v_min_u32 v2, 102, v2
    v_add_u32 v2, s46, v2
    v_min_u32 v2, 2047, v2
    v_mul_u32_u24 v2, 1280, v2
    v_and_b32 v3, 1, v0
    v_mul_u32_u24 v3, 156, v3
    s_mul_i32 s46, s40, 160
    v_add3_u32 v2, v2, v3, s46
    s_cmp_ge_u32 s2, 160
    s_cbranch_scc1 K1_PREP
    s_mul_i32 s59, s60, 160
    s_add_u32 s59, s59, s2
    s_lshr_b32 s42, s59, 8
    s_lshl_b32 s42, s42, 9
    s_bfe_u32 s43, s59, 0x40002
    s_lshl_b32 s43, s43, 5
    s_add_u32 s42, s42, s43
    s_bfe_u32 s43, s59, 0x20006
    s_lshl_b32 s43, s43, 1
    s_add_u32 s42, s42, s43
    s_and_b32 s43, s59, 3
    s_lshl_b32 s43, s43, 3
    s_add_u32 s42, s42, s43
    v_lshrrev_b32 v7, 5, v1
    v_add_u32 v7, s42, v7
    v_mul_u32_u24 v7, 1280, v7
    v_and_b32 v5, 31, v1
    v_lshl_add_u32 v4, v5, 4, v7
    v_lshl_add_u32 v5, v5, 3, v7
    s_add_u32 s58, s59, 640
    s_lshr_b32 s42, s58, 8
    s_lshl_b32 s42, s42, 9
    s_bfe_u32 s43, s58, 0x40002
    s_lshl_b32 s43, s43, 5
    s_add_u32 s42, s42, s43
    s_bfe_u32 s43, s58, 0x20006
    s_lshl_b32 s43, s43, 1
    s_add_u32 s42, s42, s43
    s_and_b32 s43, s58, 3
    s_lshl_b32 s43, s43, 3
    s_add_u32 s42, s42, s43
    v_lshrrev_b32 v7, 5, v1
    v_add_u32 v7, s42, v7
    v_mul_u32_u24 v7, 1280, v7
    v_and_b32 v9, 31, v1
    v_lshl_add_u32 v8, v9, 4, v7
    v_lshl_add_u32 v9, v9, 3, v7
    s_cmp_lt_u32 s59, 640
    s_waitcnt lgkmcnt(0)
    s_cbranch_scc0 K1_NOS
    global_load_dwordx4 v[48:51], v4, s[16:17]
    global_load_dwordx4 v[52:55], v4, s[16:17] offset:512
    global_load_dwordx2 v[56:57], v5, s[16:17] offset:1024
    s_cmp_lt_u32 s58, 880
    s_cbranch_scc0 K1_NOS
    global_load_dwordx4 v[64:67], v8, s[16:17]
    global_load_dwordx4 v[68:71], v8, s[16:17] offset:512
    global_load_dwordx2 v[72:73], v9, s[16:17] offset:1024
K1_NOS:
    s_cmp_eq_u32 s61, 0
    s_cbranch_scc1 K1_NOT
    global_load_dword v242, v2, s[16:17]
K1_NOT:
    global_load_dword v10, v6, s[18:19] nt
    global_load_dword v11, v6, s[20:21] nt
    global_load_dword v12, v6, s[22:23] nt
    global_load_dword v13, v6, s[24:25] nt
    global_load_dword v14, v6, s[26:27] nt
    global_load_dword v15, v6, s[28:29] nt
    s_mov_b64 s[8:9], s[16:17]
    s_load_dword s54, s[6:7], 0
    s_load_dwordx2 s[42:43], s[30:31], s3
    s_load_dwordx2 s[44:45], s[32:33], s3
    s_cbranch_scc1 K1_C
    s_mov_b32 s12, s6
    s_mov_b32 s13, s7
    s_mov_b32 s14, 0x1900000
    s_mov_b32 s15, 0x00020000
    v_lshlrev_b32 v235, 4, v0
    v_sub_u32 v235, 143344, v235
    v_lshlrev_b32 v236, 5, v0
    v_add_u32 v236, 4608, v236
    v_add_u32 v237, 34816, v236
    s_lshl_b32 s58, s4, 12
    s_add_u32 s58, s58, 0x1000
    v_lshlrev_b32 v5, 4, v1
    v_add_u32 v239, 5120, v238
    s_waitcnt vmcnt(0)
    global_load_dwordx2 v[32:33], v238, s[8:9] offset:0
    global_load_dwordx2 v[34:35], v238, s[8:9] offset:1280
    s_branch K1_C0
K1_C:
    s_mul_i32 s56, s4, 4608
    s_add_u32 s56, s56, 139264
    s_mul_i32 s46, s4, 1280
    s_add_u32 s46, s46, 158208
    s_mov_b32 m0, s46
    v_mov_b64 v[240:241], 0
    v_and_b32 v46, 31, v1
    v_lshrrev_b32 v47, 5, v1
    v_mul_u32_u24 v228, 272, v46
    v_lshl_add_u32 v228, v47, 4, v228
    v_add_u32 v228, s55, v228
    v_lshlrev_b32 v2, 4, v46
    v_add_u32 v2, s55, v2
    v_lshl_add_u32 v229, v47, 3, v2
    v_lshl_add_u32 v230, v47, 9, v2
    v_and_b32 v2, 1, v46
    v_mul_u32_u24 v2, 640, v2
    v_and_b32 v3, 30, v46
    v_lshl_add_u32 v3, v47, 5, v3
    v_sub_u32 v2, v2, v3
    v_add_u32 v231, s46, v2
    v_lshl_add_u32 v2, v1, 3, s56
    ds_write_b64 v2, v[240:241] offset:4096
    ds_write_addtid_b32 v240 offset:0
    ds_write_addtid_b32 v240 offset:256
    ds_write_addtid_b32 v240 offset:512
    ds_write_addtid_b32 v240 offset:768
    ds_write_addtid_b32 v240 offset:1024
    s_mov_b32 s12, s6
    s_mov_b32 s13, s7
    s_mov_b32 s14, 0x1900000
    s_mov_b32 s15, 0x00020000
    v_and_b32 v2, 15, v1
    v_lshrrev_b32 v3, 4, v1
    v_add_u32 v4, 1, v2
    v_and_b32 v5, 1, v4
    v_mul_u32_u24 v5, 2240, v5
    v_and_b32 v4, 0xfffe, v4
    v_lshl_add_u32 v4, v4, 1, v5
    v_lshl_add_u32 v4, v3, 4, v4
    v_add_u32 v232, s55, v4
    v_add_u32 v233, 1024, v232
    v_add_u32 v239, 2048, v232
    v_lshlrev_b32 v4, 5, v2
    v_lshlrev_b32 v5, 4, v3
    v_sub_u32 v234, v5, v4
    v_add_u32 v234, 480, v234
    v_add_u32 v234, s56, v234
    v_lshl_add_u32 v235, v2, 6, v5
    v_add_u32 v235, s55, v235
    v_sub_u32 v6, 15, v2
    v_lshl_add_u32 v6, v3, 2, v6
    v_and_b32 v7, 1, v6
    v_mul_u32_u24 v7, 320, v7
    v_and_b32 v6, 0xfffe, v6
    v_lshl_add_u32 v6, v6, 1, v7
    v_add3_u32 v236, v6, 4, s46
    v_lshrrev_b32 v5, 1, v3
    v_lshl_add_u32 v4, v5, 4, v4
    v_and_b32 v5, 1, v3
    v_lshl_add_u32 v237, v5, 9, v4
    v_cmp_eq_u32 s[36:37], 7, v1
    v_cmp_gt_u32 s[38:39], 2, v1
    v_cmp_eq_u32 s[48:49], 2, v1
    v_cmp_eq_u32 s[50:51], 0, v1
    v_lshl_add_u32 v4, v3, 3, v2
    s_mov_b32 s46, 0x10001
    v_add_u32 v5, 0, v4
    v_min_u32 v5, 31, v5
    v_mov_b32 v6, 0x7f00000
    v_lshrrev_b32 v6, v5, v6
    v_and_b32 v6, 0xff, v6
    v_lshl_or_b32 v6, v6, 15, v6
    v_lshrrev_b32 v7, 0, v6
    v_and_b32 v7, s46, v7
    v_mul_u32_u24 v244, 0x3f80, v7
    v_lshrrev_b32 v7, 2, v6
    v_and_b32 v7, s46, v7
    v_mul_u32_u24 v245, 0x3f80, v7
    v_lshrrev_b32 v7, 4, v6
    v_and_b32 v7, s46, v7
    v_mul_u32_u24 v246, 0x3f80, v7
    v_lshrrev_b32 v7, 6, v6
    v_and_b32 v7, s46, v7
    v_mul_u32_u24 v247, 0x3f80, v7
    v_add_u32 v5, 1, v4
    v_min_u32 v5, 31, v5
    v_mov_b32 v6, 0x1ff00000
    v_lshrrev_b32 v6, v5, v6
    v_and_b32 v6, 0xff, v6
    v_lshl_or_b32 v6, v6, 15, v6
    v_lshrrev_b32 v7, 0, v6
    v_and_b32 v7, s46, v7
    v_mul_u32_u24 v248, 0x3f80, v7
    v_lshrrev_b32 v7, 2, v6
    v_and_b32 v7, s46, v7
    v_mul_u32_u24 v249, 0x3f80, v7
    v_lshrrev_b32 v7, 4, v6
    v_and_b32 v7, s46, v7
    v_mul_u32_u24 v250, 0x3f80, v7
    v_lshrrev_b32 v7, 6, v6
    v_and_b32 v7, s46, v7
    v_mul_u32_u24 v251, 0x3f80, v7
    s_cmp_lt_u32 s59, 640
    s_cbranch_scc0 K1_CW
    s_lshl_b32 s59, s59, 4
    s_add_u32 s59, s59, 0x1000
    s_waitcnt vmcnt(6) lgkmcnt(0)
    s_add_u32 s53, s54, 0x9e3779b9
    s_waitcnt vmcnt(0)
K1_CS:
    v_mov_b32 v60, 0
    v_mov_b32 v61, 0
    v_mov_b32 v62, 0x3f803f80
    v_lshrrev_b32 v63, 5, v1
    v_lshlrev_b32 v63, 3, v63
    v_dot2c_f32_bf16 v60, v62, v48
    v_dot2c_f32_bf16 v61, v48, v48
    v_dot2c_f32_bf16 v60, v62, v49
    v_dot2c_f32_bf16 v61, v49, v49
    v_dot2c_f32_bf16 v60, v62, v50
    v_dot2c_f32_bf16 v61, v50, v50
    v_dot2c_f32_bf16 v60, v62, v51
    v_dot2c_f32_bf16 v61, v51, v51
    v_dot2c_f32_bf16 v60, v62, v52
    v_dot2c_f32_bf16 v61, v52, v52
    v_dot2c_f32_bf16 v60, v62, v53
    v_dot2c_f32_bf16 v61, v53, v53
    v_dot2c_f32_bf16 v60, v62, v54
    v_dot2c_f32_bf16 v61, v54, v54
    v_dot2c_f32_bf16 v60, v62, v55
    v_dot2c_f32_bf16 v61, v55, v55
    v_dot2c_f32_bf16 v60, v62, v56
    v_dot2c_f32_bf16 v61, v56, v56
    v_dot2c_f32_bf16 v60, v62, v57
    v_dot2c_f32_bf16 v61, v57, v57
    s_nop 2
    v_add_f32_dpp v60, v60, v60 row_ror:8 row_mask:0xf bank_mask:0xf
    v_add_f32_dpp v61, v61, v61 row_ror:8 row_mask:0xf bank_mask:0xf
    s_nop 0
    v_add_f32_dpp v60, v60, v60 row_ror:4 row_mask:0xf bank_mask:0xf
    v_add_f32_dpp v61, v61, v61 row_ror:4 row_mask:0xf bank_mask:0xf
    s_nop 0
    v_add_f32_dpp v60, v60, v60 row_ror:2 row_mask:0xf bank_mask:0xf
    v_add_f32_dpp v61, v61, v61 row_ror:2 row_mask:0xf bank_mask:0xf
    s_nop 0
    v_add_f32_dpp v60, v60, v60 row_ror:1 row_mask:0xf bank_mask:0xf
    v_add_f32_dpp v61, v61, v61 row_ror:1 row_mask:0xf bank_mask:0xf
    s_nop 0
    v_mov_b32 v58, v60
    v_mov_b32 v59, v61
    s_nop 1
    v_permlane16_swap_b32 v60, v58
    v_permlane16_swap_b32 v61, v59
    s_nop 0
    v_pk_add_f32 v[60:61], v[60:61], v[58:59]
    v_mul_f32 v60, 0x3acccccd, v60
    v_mul_f32 v61, 0x3acccccd, v61
    v_fma_f32 v61, -v60, v60, v61
    v_max_f32 v61, 0, v61
    v_cvt_pk_bf16_f32 v61, v61, v61
    v_lshlrev_b32 v61, 16, v61
    v_add_f32 v61, 0x3727c5ac, v61
    v_cvt_pk_bf16_f32 v61, v61, v61
    v_lshlrev_b32 v61, 16, v61
    v_sqrt_f32 v61, v61
    s_nop 0
    v_cvt_pk_bf16_f32 v60, v60, v61
    v_mov_b32 v61, s53
    s_mov_b32 exec_lo, 1
    s_mov_b32 exec_hi, 1
    buffer_store_dwordx2 v[60:61], v63, s[12:15], s59 offen sc1
    s_mov_b64 exec, -1
    v_mov_b64 v[48:49], v[64:65]
    v_mov_b64 v[50:51], v[66:67]
    v_mov_b64 v[52:53], v[68:69]
    v_mov_b64 v[54:55], v[70:71]
    v_mov_b64 v[56:57], v[72:73]
    s_add_u32 s59, s59, 10240
    s_cmp_lt_u32 s59, 0x4700
    s_cbranch_scc1 K1_CS
    s_branch K1_C0
K1_CW:
    s_waitcnt vmcnt(0)
K1_C0:
    s_lshl_b32 s62, s4, 4
    s_mov_b32 s59, s61
    s_waitcnt lgkmcnt(0)
    s_add_u32 s54, s54, 0x9e3779b9
    s_lshr_b64 s[42:43], s[42:43], s62
    s_lshl_b32 s42, s42, 16
    v_mov_b32 v9, s42
    v_mul_f32 v9, 0x3fb8aa3b, v9
    v_exp_f32 v9, v9
    s_nop 0
    v_cvt_pk_bf16_f32 v9, v9, v9
    v_lshlrev_b32 v9, 16, v9
K1_PASS:
    s_mul_i32 s56, s59, 69632
    s_add_u32 s56, s56, s55
    s_mov_b32 m0, s56
    s_lshl_b32 s47, s59, 4
    v_lshrrev_b32 v60, s47, v10
    v_lshrrev_b32 v61, s47, v11
    v_lshlrev_b32 v60, 16, v60
    v_lshlrev_b32 v61, 16, v61
    v_mul_f32 v60, v60, v9
    v_mul_f32 v61, v61, v9
    v_mul_f32 v68, 0x3fb8aa3b, v60
    v_mul_f32 v69, 0.15915494, v61
    s_sub_u32 s46, s60, 4
    s_cmp_ge_u32 s46, 4
    v_mul_f32 v62, 0x41000000, v68
    v_mul_f32 v63, 0x41000000, v69
    v_fract_f32 v63, v63
    v_exp_f32 v62, v62
    v_cos_f32 v50, v63
    v_sin_f32 v51, v63
    v_mov_b32 v95, 0x3f80
    .p2align 3
    ds_write_addtid_b32 v95 offset:0
    v_pk_mul_f32 v[50:51], v[50:51], v[62:63] op_sel_hi:[1,0]
    v_pk_mul_f32 v[52:53], v[50:51], v[50:51] op_sel_hi:[1,0]
    v_pk_fma_f32 v[52:53], v[50:51], v[50:51], v[52:53] op_sel:[1,1,0] op_sel_hi:[0,1,1] neg_lo:[1,0,0]
    v_cvt_pk_bf16_f32 v90, v50, v51
    ds_write_addtid_b32 v90 offset:272
    v_cvt_pk_bf16_f32 v91, v52, v53
    ds_write_addtid_b32 v91 offset:544
    v_pk_mul_f32 v[66:67], v[50:51], v[52:53] op_sel_hi:[1,0]
    v_pk_fma_f32 v[66:67], v[50:51], v[52:53], v[66:67] op_sel:[1,1,0] op_sel_hi:[0,1,1] neg_lo:[1,0,0]
    v_cvt_pk_bf16_f32 v92, v66, v67
    ds_write_addtid_b32 v92 offset:816
    v_pk_mul_f32 v[60:61], v[52:53], v[52:53] op_sel_hi:[1,0]
    v_pk_fma_f32 v[60:61], v[52:53], v[52:53], v[60:61] op_sel:[1,1,0] op_sel_hi:[0,1,1] neg_lo:[1,0,0]
    v_cvt_pk_bf16_f32 v93, v60, v61
    ds_write_addtid_b32 v93 offset:1088
    v_pk_mul_f32 v[62:63], v[66:67], v[52:53] op_sel_hi:[1,0]
    v_pk_fma_f32 v[62:63], v[66:67], v[52:53], v[62:63] op_sel:[1,1,0] op_sel_hi:[0,1,1] neg_lo:[1,0,0]
    v_cvt_pk_bf16_f32 v94, v62, v63
    ds_write_addtid_b32 v94 offset:1360
    v_pk_mul_f32 v[64:65], v[60:61], v[52:53] op_sel_hi:[1,0]
    v_pk_fma_f32 v[64:65], v[60:61], v[52:53], v[64:65] op_sel:[1,1,0] op_sel_hi:[0,1,1] neg_lo:[1,0,0]
    v_cvt_pk_bf16_f32 v95, v64, v65
    ds_write_addtid_b32 v95 offset:1632
    v_pk_mul_f32 v[66:67], v[62:63], v[52:53] op_sel_hi:[1,0]
    v_pk_fma_f32 v[66:67], v[62:63], v[52:53], v[66:67] op_sel:[1,1,0] op_sel_hi:[0,1,1] neg_lo:[1,0,0]
    v_cvt_pk_bf16_f32 v90, v66, v67
    ds_write_addtid_b32 v90 offset:1904
    v_pk_mul_f32 v[60:61], v[64:65], v[52:53] op_sel_hi:[1,0]
    v_pk_fma_f32 v[60:61], v[64:65], v[52:53], v[60:61] op_sel:[1,1,0] op_sel_hi:[0,1,1] neg_lo:[1,0,0]
    v_cvt_pk_bf16_f32 v91, v60, v61
    ds_write_addtid_b32 v91 offset:2176
    s_cbranch_scc1 K1_NG2
    global_load_dwordx2 v[36:37], v238, s[8:9] offset:2560
K1_NG2:
    s_nop 0
    v_pk_mul_f32 v[62:63], v[66:67], v[52:53] op_sel_hi:[1,0]
    v_pk_fma_f32 v[62:63], v[66:67], v[52:53], v[62:63] op_sel:[1,1,0] op_sel_hi:[0,1,1] neg_lo:[1,0,0]
    v_cvt_pk_bf16_f32 v92, v62, v63
    ds_write_addtid_b32 v92 offset:2448
    v_pk_mul_f32 v[64:65], v[60:61], v[52:53] op_sel_hi:[1,0]
    v_pk_fma_f32 v[64:65], v[60:61], v[52:53], v[64:65] op_sel:[1,1,0] op_sel_hi:[0,1,1] neg_lo:[1,0,0]
    v_cvt_pk_bf16_f32 v93, v64, v65
    ds_write_addtid_b32 v93 offset:2720
    v_pk_mul_f32 v[66:67], v[62:63], v[52:53] op_sel_hi:[1,0]
    v_pk_fma_f32 v[66:67], v[62:63], v[52:53], v[66:67] op_sel:[1,1,0] op_sel_hi:[0,1,1] neg_lo:[1,0,0]
    v_cvt_pk_bf16_f32 v94, v66, v67
    ds_write_addtid_b32 v94 offset:2992
    v_pk_mul_f32 v[60:61], v[64:65], v[52:53] op_sel_hi:[1,0]
    v_pk_fma_f32 v[60:61], v[64:65], v[52:53], v[60:61] op_sel:[1,1,0] op_sel_hi:[0,1,1] neg_lo:[1,0,0]
    v_cvt_pk_bf16_f32 v95, v60, v61
    ds_write_addtid_b32 v95 offset:3264
    v_pk_mul_f32 v[62:63], v[66:67], v[52:53] op_sel_hi:[1,0]
    v_pk_fma_f32 v[62:63], v[66:67], v[52:53], v[62:63] op_sel:[1,1,0] op_sel_hi:[0,1,1] neg_lo:[1,0,0]
    v_cvt_pk_bf16_f32 v90, v62, v63
    ds_write_addtid_b32 v90 offset:3536
    v_pk_mul_f32 v[64:65], v[60:61], v[52:53] op_sel_hi:[1,0]
    v_pk_fma_f32 v[64:65], v[60:61], v[52:53], v[64:65] op_sel:[1,1,0] op_sel_hi:[0,1,1] neg_lo:[1,0,0]
    v_cvt_pk_bf16_f32 v91, v64, v65
    ds_write_addtid_b32 v91 offset:3808
    v_pk_mul_f32 v[66:67], v[62:63], v[52:53] op_sel_hi:[1,0]
    v_pk_fma_f32 v[66:67], v[62:63], v[52:53], v[66:67] op_sel:[1,1,0] op_sel_hi:[0,1,1] neg_lo:[1,0,0]
    v_cvt_pk_bf16_f32 v92, v66, v67
    ds_write_addtid_b32 v92 offset:4080
    v_pk_mul_f32 v[60:61], v[64:65], v[52:53] op_sel_hi:[1,0]
    v_pk_fma_f32 v[60:61], v[64:65], v[52:53], v[60:61] op_sel:[1,1,0] op_sel_hi:[0,1,1] neg_lo:[1,0,0]
    v_cvt_pk_bf16_f32 v93, v60, v61
    ds_write_addtid_b32 v93 offset:4352
    v_pk_mul_f32 v[62:63], v[66:67], v[52:53] op_sel_hi:[1,0]
    v_pk_fma_f32 v[62:63], v[66:67], v[52:53], v[62:63] op_sel:[1,1,0] op_sel_hi:[0,1,1] neg_lo:[1,0,0]
    v_cvt_pk_bf16_f32 v94, v62, v63
    ds_write_addtid_b32 v94 offset:4624
    v_pk_mul_f32 v[64:65], v[60:61], v[52:53] op_sel_hi:[1,0]
    v_pk_fma_f32 v[64:65], v[60:61], v[52:53], v[64:65] op_sel:[1,1,0] op_sel_hi:[0,1,1] neg_lo:[1,0,0]
    v_cvt_pk_bf16_f32 v95, v64, v65
    ds_write_addtid_b32 v95 offset:4896
    s_cbranch_scc1 K1_NG3
    global_load_dwordx2 v[38:39], v238, s[8:9] offset:3840
K1_NG3:
    s_nop 0
    v_pk_mul_f32 v[66:67], v[62:63], v[52:53] op_sel_hi:[1,0]
    v_pk_fma_f32 v[66:67], v[62:63], v[52:53], v[66:67] op_sel:[1,1,0] op_sel_hi:[0,1,1] neg_lo:[1,0,0]
    v_cvt_pk_bf16_f32 v90, v66, v67
    ds_write_addtid_b32 v90 offset:5168
    v_pk_mul_f32 v[60:61], v[64:65], v[52:53] op_sel_hi:[1,0]
    v_pk_fma_f32 v[60:61], v[64:65], v[52:53], v[60:61] op_sel:[1,1,0] op_sel_hi:[0,1,1] neg_lo:[1,0,0]
    v_cvt_pk_bf16_f32 v91, v60, v61
    ds_write_addtid_b32 v91 offset:5440
    v_pk_mul_f32 v[62:63], v[66:67], v[52:53] op_sel_hi:[1,0]
    v_pk_fma_f32 v[62:63], v[66:67], v[52:53], v[62:63] op_sel:[1,1,0] op_sel_hi:[0,1,1] neg_lo:[1,0,0]
    v_cvt_pk_bf16_f32 v92, v62, v63
    ds_write_addtid_b32 v92 offset:5712
    v_pk_mul_f32 v[64:65], v[60:61], v[52:53] op_sel_hi:[1,0]
    v_pk_fma_f32 v[64:65], v[60:61], v[52:53], v[64:65] op_sel:[1,1,0] op_sel_hi:[0,1,1] neg_lo:[1,0,0]
    v_cvt_pk_bf16_f32 v93, v64, v65
    ds_write_addtid_b32 v93 offset:5984
    v_pk_mul_f32 v[66:67], v[62:63], v[52:53] op_sel_hi:[1,0]
    v_pk_fma_f32 v[66:67], v[62:63], v[52:53], v[66:67] op_sel:[1,1,0] op_sel_hi:[0,1,1] neg_lo:[1,0,0]
    v_cvt_pk_bf16_f32 v94, v66, v67
    ds_write_addtid_b32 v94 offset:6256
    v_pk_mul_f32 v[60:61], v[64:65], v[52:53] op_sel_hi:[1,0]
    v_pk_fma_f32 v[60:61], v[64:65], v[52:53], v[60:61] op_sel:[1,1,0] op_sel_hi:[0,1,1] neg_lo:[1,0,0]
    v_cvt_pk_bf16_f32 v95, v60, v61
    ds_write_addtid_b32 v95 offset:6528
    v_pk_mul_f32 v[62:63], v[66:67], v[52:53] op_sel_hi:[1,0]
    v_pk_fma_f32 v[62:63], v[66:67], v[52:53], v[62:63] op_sel:[1,1,0] op_sel_hi:[0,1,1] neg_lo:[1,0,0]
    v_cvt_pk_bf16_f32 v90, v62, v63
    ds_write_addtid_b32 v90 offset:6800
    v_pk_mul_f32 v[64:65], v[60:61], v[52:53] op_sel_hi:[1,0]
    v_pk_fma_f32 v[64:65], v[60:61], v[52:53], v[64:65] op_sel:[1,1,0] op_sel_hi:[0,1,1] neg_lo:[1,0,0]
    v_cvt_pk_bf16_f32 v91, v64, v65
    ds_write_addtid_b32 v91 offset:7072
    v_pk_mul_f32 v[66:67], v[62:63], v[52:53] op_sel_hi:[1,0]
    v_pk_fma_f32 v[66:67], v[62:63], v[52:53], v[66:67] op_sel:[1,1,0] op_sel_hi:[0,1,1] neg_lo:[1,0,0]
    v_cvt_pk_bf16_f32 v92, v66, v67
    ds_write_addtid_b32 v92 offset:7344
    v_pk_mul_f32 v[60:61], v[64:65], v[52:53] op_sel_hi:[1,0]
    v_pk_fma_f32 v[60:61], v[64:65], v[52:53], v[60:61] op_sel:[1,1,0] op_sel_hi:[0,1,1] neg_lo:[1,0,0]
    v_cvt_pk_bf16_f32 v93, v60, v61
    ds_write_addtid_b32 v93 offset:7616
    s_cbranch_scc1 K1_NG4
    global_load_dwordx2 v[40:41], v239, s[8:9] offset:0
K1_NG4:
    s_nop 0
    v_pk_mul_f32 v[62:63], v[66:67], v[52:53] op_sel_hi:[1,0]
    v_pk_fma_f32 v[62:63], v[66:67], v[52:53], v[62:63] op_sel:[1,1,0] op_sel_hi:[0,1,1] neg_lo:[1,0,0]
    v_cvt_pk_bf16_f32 v94, v62, v63
    ds_write_addtid_b32 v94 offset:7888
    v_pk_mul_f32 v[64:65], v[60:61], v[52:53] op_sel_hi:[1,0]
    v_pk_fma_f32 v[64:65], v[60:61], v[52:53], v[64:65] op_sel:[1,1,0] op_sel_hi:[0,1,1] neg_lo:[1,0,0]
    v_cvt_pk_bf16_f32 v95, v64, v65
    ds_write_addtid_b32 v95 offset:8160
    v_pk_mul_f32 v[66:67], v[62:63], v[52:53] op_sel_hi:[1,0]
    v_pk_fma_f32 v[66:67], v[62:63], v[52:53], v[66:67] op_sel:[1,1,0] op_sel_hi:[0,1,1] neg_lo:[1,0,0]
    v_cvt_pk_bf16_f32 v90, v66, v67
    ds_write_addtid_b32 v90 offset:8432
    v_lshrrev_b32 v56, s47, v12
    v_lshrrev_b32 v57, s47, v13
    v_lshrrev_b32 v58, s47, v14
    v_lshrrev_b32 v59, s47, v15
    v_lshlrev_b32 v56, 16, v56
    v_lshlrev_b32 v57, 16, v57
    v_lshlrev_b32 v58, 16, v58
    v_lshlrev_b32 v59, 16, v59
    v_mul_f32 v64, 0x43800000, v68
    v_mul_f32 v65, 0x43800000, v69
    v_fract_f32 v69, v69
    v_fract_f32 v65, v65
    v_exp_f32 v68, v68
    v_exp_f32 v64, v64
    v_cos_f32 v48, v69
    v_sin_f32 v49, v69
    v_cos_f32 v54, v65
    v_sin_f32 v55, v65
    v_mul_f32 v56, v56, v9
    v_mul_f32 v57, v57, v9
    .p2align 3
    v_pk_mul_f32 v[72:73], v[58:59], v[56:57] op_sel_hi:[1,0]
    v_pk_fma_f32 v[72:73], v[58:59], v[56:57], v[72:73] op_sel:[1,1,0] op_sel_hi:[0,1,1] neg_lo:[1,0,0]
    v_pk_mul_f32 v[48:49], v[48:49], v[68:69] op_sel_hi:[1,0]
    v_pk_mul_f32 v[54:55], v[54:55], v[64:65] op_sel_hi:[1,0]
    v_cvt_pk_bf16_f32 v91, v72, -v73
    ds_write_addtid_b32 v91 offset:8704
    v_pk_mul_f32 v[74:75], v[72:73], v[48:49] op_sel_hi:[1,0]
    v_pk_fma_f32 v[74:75], v[72:73], v[48:49], v[74:75] op_sel:[1,1,0] op_sel_hi:[0,1,1] neg_lo:[1,0,0]
    v_cvt_pk_bf16_f32 v92, v74, -v75
    ds_write_addtid_b32 v92 offset:8976
    v_pk_mul_f32 v[76:77], v[74:75], v[48:49] op_sel_hi:[1,0]
    v_pk_fma_f32 v[76:77], v[74:75], v[48:49], v[76:77] op_sel:[1,1,0] op_sel_hi:[0,1,1] neg_lo:[1,0,0]
    v_cvt_pk_bf16_f32 v93, v76, -v77
    ds_write_addtid_b32 v93 offset:9248
    v_pk_mul_f32 v[78:79], v[76:77], v[48:49] op_sel_hi:[1,0]
    v_pk_fma_f32 v[78:79], v[76:77], v[48:49], v[78:79] op_sel:[1,1,0] op_sel_hi:[0,1,1] neg_lo:[1,0,0]
    v_cvt_pk_bf16_f32 v94, v78, -v79
    ds_write_addtid_b32 v94 offset:9520
    s_cbranch_scc1 K1_NG5
    global_load_dwordx2 v[42:43], v239, s[8:9] offset:1280
K1_NG5:
    s_nop 0
    v_pk_mul_f32 v[80:81], v[78:79], v[48:49] op_sel_hi:[1,0]
    v_pk_fma_f32 v[80:81], v[78:79], v[48:49], v[80:81] op_sel:[1,1,0] op_sel_hi:[0,1,1] neg_lo:[1,0,0]
    v_cvt_pk_bf16_f32 v95, v80, -v81
    ds_write_addtid_b32 v95 offset:9792
    ds_write_addtid_b32 v95 offset:10880
    v_pk_mul_f32 v[82:83], v[80:81], v[48:49] op_sel_hi:[1,0]
    v_pk_fma_f32 v[82:83], v[80:81], v[48:49], v[82:83] op_sel:[1,1,0] op_sel_hi:[0,1,1] neg_lo:[1,0,0]
    v_cvt_pk_bf16_f32 v90, v82, -v83
    ds_write_addtid_b32 v90 offset:10064
    v_pk_mul_f32 v[84:85], v[82:83], v[48:49] op_sel_hi:[1,0]
    v_pk_fma_f32 v[84:85], v[82:83], v[48:49], v[84:85] op_sel:[1,1,0] op_sel_hi:[0,1,1] neg_lo:[1,0,0]
    v_cvt_pk_bf16_f32 v91, v84, -v85
    ds_write_addtid_b32 v91 offset:10336
    v_pk_mul_f32 v[86:87], v[84:85], v[48:49] op_sel_hi:[1,0]
    v_pk_fma_f32 v[86:87], v[84:85], v[48:49], v[86:87] op_sel:[1,1,0] op_sel_hi:[0,1,1] neg_lo:[1,0,0]
    v_cvt_pk_bf16_f32 v92, v86, -v87
    ds_write_addtid_b32 v92 offset:10608
    v_pk_mul_f32 v[88:89], v[86:87], v[48:49] op_sel_hi:[1,0]
    v_pk_fma_f32 v[88:89], v[86:87], v[48:49], v[88:89] op_sel:[1,1,0] op_sel_hi:[0,1,1] neg_lo:[1,0,0]
    v_cvt_pk_bf16_f32 v93, v88, -v89
    ds_write_addtid_b32 v93 offset:11968
    v_pk_mul_f32 v[74:75], v[72:73], v[54:55] op_sel_hi:[1,0]
    v_pk_fma_f32 v[74:75], v[72:73], v[54:55], v[74:75] op_sel:[1,1,0] op_sel_hi:[0,1,1] neg_lo:[1,0,0]
    v_cvt_pk_bf16_f32 v94, v74, -v75
    ds_write_addtid_b32 v94 offset:11152
    v_pk_mul_f32 v[78:79], v[76:77], v[54:55] op_sel_hi:[1,0]
    v_pk_fma_f32 v[78:79], v[76:77], v[54:55], v[78:79] op_sel:[1,1,0] op_sel_hi:[0,1,1] neg_lo:[1,0,0]
    v_cvt_pk_bf16_f32 v95, v78, -v79
    ds_write_addtid_b32 v95 offset:11424
    v_pk_mul_f32 v[82:83], v[80:81], v[54:55] op_sel_hi:[1,0]
    v_pk_fma_f32 v[82:83], v[80:81], v[54:55], v[82:83] op_sel:[1,1,0] op_sel_hi:[0,1,1] neg_lo:[1,0,0]
    v_cvt_pk_bf16_f32 v90, v82, -v83
    ds_write_addtid_b32 v90 offset:12240
    ds_write_addtid_b32 v90 offset:11696
    v_pk_mul_f32 v[86:87], v[84:85], v[54:55] op_sel_hi:[1,0]
    v_pk_fma_f32 v[86:87], v[84:85], v[54:55], v[86:87] op_sel:[1,1,0] op_sel_hi:[0,1,1] neg_lo:[1,0,0]
    v_cvt_pk_bf16_f32 v91, v86, -v87
    ds_write_addtid_b32 v91 offset:12512
    v_pk_mul_f32 v[60:61], v[88:89], v[54:55] op_sel_hi:[1,0]
    v_pk_fma_f32 v[60:61], v[88:89], v[54:55], v[60:61] op_sel:[1,1,0] op_sel_hi:[0,1,1] neg_lo:[1,0,0]
    v_cvt_pk_bf16_f32 v92, v60, -v61
    ds_write_addtid_b32 v92 offset:12784
    v_pk_mul_f32 v[62:63], v[74:75], v[54:55] op_sel_hi:[1,0]
    v_pk_fma_f32 v[62:63], v[74:75], v[54:55], v[62:63] op_sel:[1,1,0] op_sel_hi:[0,1,1] neg_lo:[1,0,0]
    v_cvt_pk_bf16_f32 v93, v62, -v63
    ds_write_addtid_b32 v93 offset:13056
    v_pk_mul_f32 v[72:73], v[82:83], v[54:55] op_sel_hi:[1,0]
    v_pk_fma_f32 v[72:73], v[82:83], v[54:55], v[72:73] op_sel:[1,1,0] op_sel_hi:[0,1,1] neg_lo:[1,0,0]
    v_cvt_pk_bf16_f32 v94, v72, -v73
    ds_write_addtid_b32 v94 offset:13328
    v_pk_mul_f32 v[76:77], v[60:61], v[54:55] op_sel_hi:[1,0]
    v_pk_fma_f32 v[76:77], v[60:61], v[54:55], v[76:77] op_sel:[1,1,0] op_sel_hi:[0,1,1] neg_lo:[1,0,0]
    v_cvt_pk_bf16_f32 v95, v76, -v77
    ds_write_addtid_b32 v95 offset:13600
    v_pk_mul_f32 v[80:81], v[62:63], v[54:55] op_sel_hi:[1,0]
    v_pk_fma_f32 v[80:81], v[62:63], v[54:55], v[80:81] op_sel:[1,1,0] op_sel_hi:[0,1,1] neg_lo:[1,0,0]
    v_cvt_pk_bf16_f32 v90, v80, -v81
    ds_write_addtid_b32 v90 offset:14144
    v_pk_mul_f32 v[84:85], v[72:73], v[54:55] op_sel_hi:[1,0]
    v_pk_fma_f32 v[84:85], v[72:73], v[54:55], v[84:85] op_sel:[1,1,0] op_sel_hi:[0,1,1] neg_lo:[1,0,0]
    v_cvt_pk_bf16_f32 v91, v84, -v85
    ds_write_addtid_b32 v91 offset:14416
    v_pk_mul_f32 v[88:89], v[76:77], v[54:55] op_sel_hi:[1,0]
    v_pk_fma_f32 v[88:89], v[76:77], v[54:55], v[88:89] op_sel:[1,1,0] op_sel_hi:[0,1,1] neg_lo:[1,0,0]
    v_cvt_pk_bf16_f32 v92, v88, -v89
    ds_write_addtid_b32 v92 offset:14688
    v_pk_mul_f32 v[74:75], v[88:89], v[54:55] op_sel_hi:[1,0]
    v_pk_fma_f32 v[74:75], v[88:89], v[54:55], v[74:75] op_sel:[1,1,0] op_sel_hi:[0,1,1] neg_lo:[1,0,0]
    v_cvt_pk_bf16_f32 v93, v74, -v75
    ds_write_addtid_b32 v93 offset:13872
    v_pk_mul_f32 v[82:83], v[74:75], v[54:55] op_sel_hi:[1,0]
    v_pk_fma_f32 v[82:83], v[74:75], v[54:55], v[82:83] op_sel:[1,1,0] op_sel_hi:[0,1,1] neg_lo:[1,0,0]
    v_cvt_pk_bf16_f32 v94, v82, -v83
    ds_write_addtid_b32 v94 offset:14960
    v_pk_mul_f32 v[60:61], v[82:83], v[54:55] op_sel_hi:[1,0]
    v_pk_fma_f32 v[60:61], v[82:83], v[54:55], v[60:61] op_sel:[1,1,0] op_sel_hi:[0,1,1] neg_lo:[1,0,0]
    v_cvt_pk_bf16_f32 v95, v60, -v61
    ds_write_addtid_b32 v95 offset:15232
    v_pk_mul_f32 v[62:63], v[60:61], v[54:55] op_sel_hi:[1,0]
    v_pk_fma_f32 v[62:63], v[60:61], v[54:55], v[62:63] op_sel:[1,1,0] op_sel_hi:[0,1,1] neg_lo:[1,0,0]
    v_cvt_pk_bf16_f32 v90, v62, -v63
    ds_write_addtid_b32 v90 offset:16320
    s_cmp_eq_u32 s61, 0
    s_cbranch_scc1 K1_PEND
    s_mov_b32 s52, 0
    s_waitcnt lgkmcnt(0)
    s_barrier
    global_load_dwordx2 v[44:45], v239, s[8:9] offset:2560
    global_load_dwordx2 v[46:47], v239, s[8:9] offset:3840
    buffer_load_dwordx4 v[16:19], v5, s[12:15], s58 offen offset:0 sc1
    buffer_load_dwordx4 v[20:23], v5, s[12:15], s58 offen offset:1024 sc1
    buffer_load_dwordx4 v[24:27], v5, s[12:15], s58 offen offset:2048 sc1
    buffer_load_dwordx4 v[28:31], v5, s[12:15], s58 offen offset:3072 sc1
    s_branch K2_LSETUP
K1_POLL:
    buffer_load_dwordx4 v[16:19], v5, s[12:15], s58 offen offset:0 sc1
    buffer_load_dwordx4 v[20:23], v5, s[12:15], s58 offen offset:1024 sc1
    buffer_load_dwordx4 v[24:27], v5, s[12:15], s58 offen offset:2048 sc1
    buffer_load_dwordx4 v[28:31], v5, s[12:15], s58 offen offset:3072 sc1
    s_branch K1_CHK
K1_BACK:
    s_waitcnt vmcnt(8)
    v_lshlrev_b32 v48, 16, v32
    v_lshlrev_b32 v49, 16, v34
    v_lshlrev_b32 v50, 16, v36
    v_lshlrev_b32 v51, 16, v38
    ds_write_b128 v236, v[48:51] offset:0
    v_and_b32 v56, 0xffff0000, v32
    v_and_b32 v57, 0xffff0000, v34
    v_and_b32 v58, 0xffff0000, v36
    v_and_b32 v59, 0xffff0000, v38
    ds_write_b128 v236, v[56:59] offset:17408
    v_lshlrev_b32 v64, 16, v33
    v_lshlrev_b32 v65, 16, v35
    v_lshlrev_b32 v66, 16, v37
    v_lshlrev_b32 v67, 16, v39
    ds_write_b128 v237, v[64:67] offset:0
    v_and_b32 v72, 0xffff0000, v33
    v_and_b32 v73, 0xffff0000, v35
    v_and_b32 v74, 0xffff0000, v37
    v_and_b32 v75, 0xffff0000, v39
    ds_write_b128 v237, v[72:75] offset:17408
K1_CHK:
    s_add_u32 s52, s52, 1
    s_waitcnt vmcnt(0)
    v_xor_b32 v96, s54, v17
    v_xor_b32 v97, s54, v19
    v_xor_b32 v98, s54, v21
    v_xor_b32 v99, s54, v23
    v_xor_b32 v100, s54, v25
    v_xor_b32 v101, s54, v27
    v_xor_b32 v102, s54, v29
    v_xor_b32 v103, s54, v31
    v_or3_b32 v96, v96, v97, v98
    v_or3_b32 v99, v99, v100, v101
    v_or3_b32 v96, v96, v102, v103
    v_or_b32 v96, v96, v99
    v_cmp_ne_u32 vcc, 0, v96
    s_cmp_lt_u32 s52, 0x40000
    s_cbranch_vccz K1_GOT
    s_sleep 4
    s_cbranch_scc1 K1_POLL
K1_GOT:
    v_and_b32 v80, 0xffff0000, v16
    v_rcp_f32 v80, v80
    v_lshlrev_b32 v88, 16, v16
    v_and_b32 v81, 0xffff0000, v18
    v_rcp_f32 v81, v81
    v_lshlrev_b32 v89, 16, v18
    v_and_b32 v82, 0xffff0000, v20
    v_rcp_f32 v82, v82
    v_lshlrev_b32 v90, 16, v20
    v_and_b32 v83, 0xffff0000, v22
    v_rcp_f32 v83, v83
    v_lshlrev_b32 v91, 16, v22
    v_and_b32 v84, 0xffff0000, v24
    v_rcp_f32 v84, v84
    v_lshlrev_b32 v92, 16, v24
    v_and_b32 v85, 0xffff0000, v26
    v_rcp_f32 v85, v85
    v_lshlrev_b32 v93, 16, v26
    v_and_b32 v86, 0xffff0000, v28
    v_rcp_f32 v86, v86
    v_lshlrev_b32 v94, 16, v28
    v_and_b32 v87, 0xffff0000, v30
    v_rcp_f32 v87, v87
    v_lshlrev_b32 v95, 16, v30
    v_pk_mul_f32 v[88:89], v[88:89], v[80:81] neg_lo:[1,0] neg_hi:[1,0]
    v_pk_mul_f32 v[90:91], v[90:91], v[82:83] neg_lo:[1,0] neg_hi:[1,0]
    v_pk_mul_f32 v[92:93], v[92:93], v[84:85] neg_lo:[1,0] neg_hi:[1,0]
    v_pk_mul_f32 v[94:95], v[94:95], v[86:87] neg_lo:[1,0] neg_hi:[1,0]
    v_lshlrev_b32 v52, 16, v40
    v_lshlrev_b32 v53, 16, v42
    v_lshlrev_b32 v54, 16, v44
    v_lshlrev_b32 v55, 16, v46
    v_pk_fma_f32 v[112:113], v[48:49], v[80:81], v[88:89]
    v_pk_fma_f32 v[114:115], v[50:51], v[82:83], v[90:91]
    v_pk_fma_f32 v[116:117], v[52:53], v[84:85], v[92:93]
    v_pk_fma_f32 v[118:119], v[54:55], v[86:87], v[94:95]
    v_cvt_pk_bf16_f32 v96, v119, v118
    v_cvt_pk_bf16_f32 v97, v117, v116
    v_cvt_pk_bf16_f32 v98, v115, v114
    v_cvt_pk_bf16_f32 v99, v113, v112
    ds_write_b128 v235, v[96:99] offset:0
    v_and_b32 v60, 0xffff0000, v40
    v_and_b32 v61, 0xffff0000, v42
    v_and_b32 v62, 0xffff0000, v44
    v_and_b32 v63, 0xffff0000, v46
    v_pk_fma_f32 v[120:121], v[56:57], v[80:81], v[88:89]
    v_pk_fma_f32 v[122:123], v[58:59], v[82:83], v[90:91]
    v_pk_fma_f32 v[124:125], v[60:61], v[84:85], v[92:93]
    v_pk_fma_f32 v[126:127], v[62:63], v[86:87], v[94:95]
    v_cvt_pk_bf16_f32 v100, v127, v126
    v_cvt_pk_bf16_f32 v101, v125, v124
    v_cvt_pk_bf16_f32 v102, v123, v122
    v_cvt_pk_bf16_f32 v103, v121, v120
    ds_write_b128 v235, v[100:103] offset:4608
    v_lshlrev_b32 v68, 16, v41
    v_lshlrev_b32 v69, 16, v43
    v_lshlrev_b32 v70, 16, v45
    v_lshlrev_b32 v71, 16, v47
    v_pk_fma_f32 v[128:129], v[64:65], v[80:81], v[88:89]
    v_pk_fma_f32 v[130:131], v[66:67], v[82:83], v[90:91]
    v_pk_fma_f32 v[132:133], v[68:69], v[84:85], v[92:93]
    v_pk_fma_f32 v[134:135], v[70:71], v[86:87], v[94:95]
    v_cvt_pk_bf16_f32 v104, v135, v134
    v_cvt_pk_bf16_f32 v105, v133, v132
    v_cvt_pk_bf16_f32 v106, v131, v130
    v_cvt_pk_bf16_f32 v107, v129, v128
    ds_write_b128 v235, v[104:107] offset:9216
    v_and_b32 v76, 0xffff0000, v41
    v_and_b32 v77, 0xffff0000, v43
    v_and_b32 v78, 0xffff0000, v45
    v_and_b32 v79, 0xffff0000, v47
    v_pk_fma_f32 v[136:137], v[72:73], v[80:81], v[88:89]
    v_pk_fma_f32 v[138:139], v[74:75], v[82:83], v[90:91]
    v_pk_fma_f32 v[140:141], v[76:77], v[84:85], v[92:93]
    v_pk_fma_f32 v[142:143], v[78:79], v[86:87], v[94:95]
    v_cvt_pk_bf16_f32 v108, v143, v142
    v_cvt_pk_bf16_f32 v109, v141, v140
    v_cvt_pk_bf16_f32 v110, v139, v138
    v_cvt_pk_bf16_f32 v111, v137, v136
    ds_write_b128 v235, v[108:111] offset:13824
    s_waitcnt lgkmcnt(0)
    s_barrier
K1_NB:
    buffer_load_dword v6, v10, s[12:15], 0 offen sc1
    s_setprio 3
    ds_write_b128 v236, v[52:55] offset:16
    ds_write_b128 v236, v[60:63] offset:17424
    ds_write_b128 v237, v[68:71] offset:16
    ds_write_b128 v237, v[76:79] offset:17424
    s_setprio 0
    s_lshl_b32 s52, s4, 8
    s_add_u32 s52, s52, s2
    s_sub_u32 s52, s52, 54
    s_cmp_ge_u32 s52, 42
    s_cbranch_scc1 K1_NOBUMP
    v_and_b32 v14, 31, v1
    v_lshlrev_b32 v14, 2, v14
    v_mov_b32 v15, s54
    s_lshl_b32 s52, s2, 7
    s_add_u32 s52, s52, 0x1870000
    s_mov_b32 exec_hi, 0
    buffer_store_dword v15, v14, s[12:15], s52 offen sc1
    s_mov_b32 exec_hi, -1
K1_NOBUMP:
    s_branch K2_LOADER
K1_PEND:
    s_mov_b32 m0, s55
    s_waitcnt lgkmcnt(0)
    ds_read_b128 v[112:115], v228 offset:8704
    ds_read_b128 v[144:147], v228 offset:0
    ds_read_b128 v[116:119], v228 offset:8736
    ds_read_b128 v[148:151], v228 offset:32
    ds_read_b128 v[120:123], v228 offset:8768
    ds_read_b128 v[152:155], v228 offset:64
    ds_read_b128 v[124:127], v228 offset:8800
    ds_read_b128 v[156:159], v228 offset:96
    ds_read_b128 v[128:131], v228 offset:8832
    ds_read_b128 v[160:163], v228 offset:128
    ds_read_b128 v[132:135], v228 offset:8864
    ds_read_b128 v[164:167], v228 offset:160
    ds_read_b128 v[136:139], v228 offset:8896
    ds_read_b128 v[168:171], v228 offset:192
    ds_read_b128 v[140:143], v228 offset:8928
    ds_read_b128 v[172:175], v228 offset:224
    s_waitcnt lgkmcnt(14)
    v_mfma_f32_32x32x16_bf16 v[96:111], v[112:115], v[144:147], 0
    s_waitcnt lgkmcnt(12)
    v_mfma_f32_32x32x16_bf16 v[96:111], v[116:119], v[148:151], v[96:111]
    s_waitcnt lgkmcnt(10)
    v_mfma_f32_32x32x16_bf16 v[96:111], v[120:123], v[152:155], v[96:111]
    s_waitcnt lgkmcnt(8)
    v_mfma_f32_32x32x16_bf16 v[96:111], v[124:127], v[156:159], v[96:111]
    s_waitcnt lgkmcnt(6)
    v_mfma_f32_32x32x16_bf16 v[96:111], v[128:131], v[160:163], v[96:111]
    s_waitcnt lgkmcnt(4)
    v_mfma_f32_32x32x16_bf16 v[96:111], v[132:135], v[164:167], v[96:111]
    s_waitcnt lgkmcnt(2)
    v_mfma_f32_32x32x16_bf16 v[96:111], v[136:139], v[168:171], v[96:111]
    s_waitcnt lgkmcnt(0)
    v_mfma_f32_32x32x16_bf16 v[96:111], v[140:143], v[172:175], v[96:111]
    s_barrier
    s_setprio 0
    v_add_u32 v228, 69632, v228
    ds_read_b128 v[112:115], v228 offset:8704
    ds_read_b128 v[144:147], v228 offset:0
    ds_read_b128 v[116:119], v228 offset:8736
    ds_read_b128 v[148:151], v228 offset:32
    ds_read_b128 v[120:123], v228 offset:8768
    ds_read_b128 v[152:155], v228 offset:64
    ds_read_b128 v[124:127], v228 offset:8800
    ds_read_b128 v[156:159], v228 offset:96
    ds_read_b128 v[128:131], v228 offset:8832
    ds_read_b128 v[160:163], v228 offset:128
    ds_read_b128 v[132:135], v228 offset:8864
    ds_read_b128 v[164:167], v228 offset:160
    ds_read_b128 v[136:139], v228 offset:8896
    ds_read_b128 v[168:171], v228 offset:192
    ds_read_b128 v[140:143], v228 offset:8928
    ds_read_b128 v[172:175], v228 offset:224
    s_waitcnt lgkmcnt(14)
    v_mfma_f32_32x32x16_bf16 v[96:111], v[112:115], v[144:147], v[96:111]
    s_waitcnt lgkmcnt(12)
    v_mfma_f32_32x32x16_bf16 v[96:111], v[116:119], v[148:151], v[96:111]
    s_waitcnt lgkmcnt(10)
    v_mfma_f32_32x32x16_bf16 v[96:111], v[120:123], v[152:155], v[96:111]
    s_waitcnt lgkmcnt(8)
    v_mfma_f32_32x32x16_bf16 v[96:111], v[124:127], v[156:159], v[96:111]
    s_waitcnt lgkmcnt(6)
    v_mfma_f32_32x32x16_bf16 v[96:111], v[128:131], v[160:163], v[96:111]
    s_waitcnt lgkmcnt(4)
    v_mfma_f32_32x32x16_bf16 v[96:111], v[132:135], v[164:167], v[96:111]
    s_waitcnt lgkmcnt(2)
    v_mfma_f32_32x32x16_bf16 v[96:111], v[136:139], v[168:171], v[96:111]
    s_waitcnt lgkmcnt(0)
    v_mfma_f32_32x32x16_bf16 v[96:111], v[140:143], v[172:175], v[96:111]
    s_mov_b64 exec, 0xff
    ds_write_addtid_b32 v240
    s_mov_b64 exec, -1
    s_lshr_b64 s[44:45], s[44:45], s62
    s_lshl_b32 s44, s44, 16
    v_mov_b32 v2, s44
    v_cndmask_b32 v2, 0, v2, s[50:51]
    s_nop 4
    v_add_f32 v96, v96, v2
    v_readlane_b32 s52, v106, 63
    v_readfirstlane_b32 s53, v96
    v_cvt_pk_bf16_f32 v112, v96, v97
    v_cvt_pk_bf16_f32 v113, v98, v99
    v_cvt_pk_bf16_f32 v114, v97, v98
    v_cvt_pk_bf16_f32 v115, v99, v100
    ds_write_b64 v229, v[112:113] offset:32
    ds_write_b64 v229, v[114:115] offset:2272
    v_cvt_pk_bf16_f32 v116, v101, v101
    v_cvt_pk_bf16_f32 v117, v102, v103
    v_cvt_pk_bf16_f32 v118, v101, v102
    v_cvt_pk_bf16_f32 v119, v103, v103
    ds_write_b64 v229, v[116:117] offset:544
    ds_write_b64 v229, v[118:119] offset:2784
    v_cvt_pk_bf16_f32 v120, v104, v104
    v_cvt_pk_bf16_f32 v121, v104, v105
    v_cvt_pk_bf16_f32 v122, v105, v105
    v_cvt_pk_bf16_f32 v123, v106, v106
    v_cvt_pk_bf16_f32 v124, v104, v104
    v_cvt_pk_bf16_f32 v125, v105, v105
    v_cvt_pk_bf16_f32 v126, v105, v106
    v_cvt_pk_bf16_f32 v127, v106, v106
    ds_write_b128 v230, v[120:123] offset:1056
    ds_write_b128 v230, v[124:127] offset:3296
    v_cvt_pk_bf16_f32 v2, 0, s53
    v_cvt_pk_bf16_f32 v3, s52, s52
    v_cvt_pk_bf16_f32 v4, s52, 0
    v_cndmask_b32 v2, 0, v2, s[36:37]
    v_cndmask_b32 v3, 0, v3, s[38:39]
    v_cndmask_b32 v4, v3, v4, s[48:49]
    s_mov_b64 exec, 0xff
    ds_write_addtid_b32 v2 offset:2240
    s_mov_b64 exec, 0xffff
    ds_write_addtid_b32 v4 offset:2080
    ds_write_addtid_b32 v3 offset:4320
    s_mov_b64 exec, -1
    v_cvt_pk_bf16_f32 v5, v107, v108
    ds_write_b16 v231, v5 offset:130
    ds_write_b16 v231, v5 offset:448
    ds_write_b16_d16_hi v231, v5 offset:66
    ds_write_b16_d16_hi v231, v5 offset:384
    ds_read2_b32 v[224:225], v239 offset0:0 offset1:1
    ds_read2_b32 v[226:227], v239 offset0:2 offset1:3
    ds_read2_b32 v[48:49], v232 offset0:0 offset1:1
    ds_read2_b32 v[50:51], v232 offset0:2 offset1:3
    ds_read2_b32 v[52:53], v232 offset0:128 offset1:129
    ds_read2_b32 v[54:55], v232 offset0:130 offset1:131
    ds_read2_b32 v[56:57], v233 offset0:0 offset1:1
    ds_read2_b32 v[58:59], v233 offset0:2 offset1:3
    ds_read2_b32 v[60:61], v233 offset0:128 offset1:129
    ds_read2_b32 v[62:63], v233 offset0:130 offset1:131
    ds_read2_b32 v[144:145], v236 offset0:24 offset1:25
    ds_read2_b32 v[146:147], v236 offset0:32 offset1:33
    ds_read2_b32 v[148:149], v236 offset0:184 offset1:185
    ds_read2_b32 v[150:151], v236 offset0:192 offset1:193
    ds_read2_b32 v[64:65], v232 offset0:16 offset1:17
    ds_read2_b32 v[66:67], v232 offset0:18 offset1:19
    ds_read2_b32 v[68:69], v232 offset0:144 offset1:145
    ds_read2_b32 v[70:71], v232 offset0:146 offset1:147
    ds_read2_b32 v[72:73], v233 offset0:16 offset1:17
    ds_read2_b32 v[74:75], v233 offset0:18 offset1:19
    ds_read2_b32 v[76:77], v233 offset0:144 offset1:145
    ds_read2_b32 v[78:79], v233 offset0:146 offset1:147
    ds_read2_b32 v[80:81], v232 offset0:32 offset1:33
    ds_read2_b32 v[82:83], v232 offset0:34 offset1:35
    ds_read2_b32 v[84:85], v232 offset0:160 offset1:161
    ds_read2_b32 v[86:87], v232 offset0:162 offset1:163
    ds_read2_b32 v[88:89], v233 offset0:32 offset1:33
    ds_read2_b32 v[90:91], v233 offset0:34 offset1:35
    ds_read2_b32 v[92:93], v233 offset0:160 offset1:161
    ds_read2_b32 v[94:95], v233 offset0:162 offset1:163
    ds_read2_b32 v[96:97], v232 offset0:48 offset1:49
    ds_read2_b32 v[98:99], v232 offset0:50 offset1:51
    ds_read2_b32 v[100:101], v232 offset0:176 offset1:177
    ds_read2_b32 v[102:103], v232 offset0:178 offset1:179
    ds_read2_b32 v[104:105], v233 offset0:48 offset1:49
    ds_read2_b32 v[106:107], v233 offset0:50 offset1:51
    ds_read2_b32 v[108:109], v233 offset0:176 offset1:177
    ds_read2_b32 v[110:111], v233 offset0:178 offset1:179
    v_mov_b64 v[166:167], 0
    v_mov_b64 v[170:171], 0
    s_lshl_b32 s47, s5, 12
    s_add_u32 s47, s47, 0x10000
    v_and_b32 v2, 15, v1
    v_lshrrev_b32 v3, 4, v1
    v_lshlrev_b32 v2, 5, v2
    v_lshl_add_u32 v238, v3, 3, v2
    v_mov_b32 v2, 163328
    v_mov_b32 v3, 1
    s_setprio 0
    s_barrier
    s_waitcnt lgkmcnt(0)
    ds_read_b128 v[176:179], v234 offset:3584
    ds_read_b128 v[152:155], v234 offset:3600
    ds_read_b128 v[180:183], v234 offset:3072
    ds_read_b128 v[184:187], v234 offset:2560
    ds_read_b128 v[188:191], v234 offset:2048
    ds_read_b128 v[192:195], v234 offset:1536
    s_waitcnt lgkmcnt(5)
    v_mfma_f32_16x16x32_bf16 v[156:159], v[176:179], v[244:247], 0
    s_waitcnt lgkmcnt(4)
    v_mfma_f32_16x16x32_bf16 v[160:163], v[152:155], v[248:251], 0
    v_mfma_f32_16x16x32_bf16 v[16:19], v[48:51], v[176:179], 0
    ds_read_b128 v[200:203], v234 offset:3648
    v_mfma_f32_16x16x32_bf16 v[20:23], v[52:55], v[176:179], 0
    ds_read_b128 v[204:207], v234 offset:3136
    v_mfma_f32_16x16x32_bf16 v[24:27], v[56:59], v[176:179], 0
    ds_read_b128 v[208:211], v234 offset:2624
    v_mfma_f32_16x16x32_bf16 v[28:31], v[60:63], v[176:179], 0
    ds_read_b128 v[212:215], v234 offset:2112
    s_waitcnt lgkmcnt(7)
    v_mfma_f32_16x16x32_bf16 v[20:23], v[48:51], v[180:183], v[20:23]
    ds_read_b128 v[216:219], v234 offset:1600
    v_mfma_f32_16x16x32_bf16 v[24:27], v[52:55], v[180:183], v[24:27]
    ds_read2_b32 v[112:113], v232 offset0:64 offset1:65
    v_mfma_f32_16x16x32_bf16 v[28:31], v[56:59], v[180:183], v[28:31]
    ds_read2_b32 v[114:115], v232 offset0:66 offset1:67
    v_mfma_f32_16x16x32_bf16 v[32:35], v[60:63], v[180:183], 0
    ds_read2_b32 v[116:117], v232 offset0:192 offset1:193
    s_waitcnt lgkmcnt(10)
    v_mfma_f32_16x16x32_bf16 v[24:27], v[48:51], v[184:187], v[24:27]
    ds_read2_b32 v[118:119], v232 offset0:194 offset1:195
    v_cvt_pk_bf16_f32 v164, v156, v157
    v_mfma_f32_16x16x32_bf16 v[28:31], v[52:55], v[184:187], v[28:31]
    ds_read2_b32 v[120:121], v233 offset0:64 offset1:65
    v_cvt_pk_bf16_f32 v165, v158, v159
    v_mfma_f32_16x16x32_bf16 v[32:35], v[56:59], v[184:187], v[32:35]
    ds_read2_b32 v[122:123], v233 offset0:66 offset1:67
    v_cvt_pk_bf16_f32 v168, v160, v161
    s_waitcnt lgkmcnt(12)
    v_mfma_f32_16x16x32_bf16 v[28:31], v[48:51], v[188:191], v[28:31]
    ds_read2_b32 v[124:125], v233 offset0:192 offset1:193
    v_cvt_pk_bf16_f32 v169, v162, v163
    v_mfma_f32_16x16x32_bf16 v[32:35], v[52:55], v[188:191], v[32:35]
    ds_read2_b32 v[126:127], v233 offset0:194 offset1:195
    s_waitcnt lgkmcnt(13)
    v_mfma_f32_16x16x32_bf16 v[32:35], v[48:51], v[192:195], v[32:35]
    v_mfma_f32_16x16x32_bf16 v[32:35], v[224:227], v[176:179], v[32:35]
    v_mfma_f32_16x16x32_bf16 v[32:35], v[164:167], v[144:147], v[32:35]
    ds_read_b128 v[176:179], v234 offset:3712
    v_mfma_f32_16x16x32_bf16 v[32:35], v[168:171], v[148:151], v[32:35]
    ds_read_b128 v[180:183], v234 offset:3200
    s_waitcnt lgkmcnt(14)
    v_mfma_f32_16x16x32_bf16 v[16:19], v[64:67], v[200:203], v[16:19]
    ds_read_b128 v[184:187], v234 offset:2688
    v_mfma_f32_16x16x32_bf16 v[20:23], v[68:71], v[200:203], v[20:23]
    ds_read_b128 v[188:191], v234 offset:2176
    v_mfma_f32_16x16x32_bf16 v[24:27], v[72:75], v[200:203], v[24:27]
    ds_read_b128 v[192:195], v234 offset:1664
    v_mfma_f32_16x16x32_bf16 v[28:31], v[76:79], v[200:203], v[28:31]
    ds_read2_b32 v[128:129], v232 offset0:80 offset1:81
    s_waitcnt lgkmcnt(15)
    v_mfma_f32_16x16x32_bf16 v[20:23], v[64:67], v[204:207], v[20:23]
    ds_read2_b32 v[130:131], v232 offset0:82 offset1:83
    v_mfma_f32_16x16x32_bf16 v[24:27], v[68:71], v[204:207], v[24:27]
    ds_read2_b32 v[132:133], v232 offset0:208 offset1:209
    v_mfma_f32_16x16x32_bf16 v[28:31], v[72:75], v[204:207], v[28:31]
    ds_read2_b32 v[134:135], v232 offset0:210 offset1:211
    v_mfma_f32_16x16x32_bf16 v[32:35], v[76:79], v[204:207], v[32:35]
    ds_read2_b32 v[136:137], v233 offset0:80 offset1:81
    v_mfma_f32_16x16x32_bf16 v[24:27], v[64:67], v[208:211], v[24:27]
    ds_read2_b32 v[138:139], v233 offset0:82 offset1:83
    v_mfma_f32_16x16x32_bf16 v[28:31], v[68:71], v[208:211], v[28:31]
    ds_read2_b32 v[140:141], v233 offset0:208 offset1:209
    v_mfma_f32_16x16x32_bf16 v[32:35], v[72:75], v[208:211], v[32:35]
    ds_read2_b32 v[142:143], v233 offset0:210 offset1:211
    v_mfma_f32_16x16x32_bf16 v[28:31], v[64:67], v[212:215], v[28:31]
    v_mfma_f32_16x16x32_bf16 v[32:35], v[68:71], v[212:215], v[32:35]
    s_waitcnt lgkmcnt(15)
    v_mfma_f32_16x16x32_bf16 v[32:35], v[64:67], v[216:219], v[32:35]
    s_waitcnt lgkmcnt(12)
    v_mfma_f32_16x16x32_bf16 v[16:19], v[80:83], v[176:179], v[16:19]
    ds_read_b128 v[200:203], v234 offset:3776
    v_mfma_f32_16x16x32_bf16 v[20:23], v[84:87], v[176:179], v[20:23]
    ds_read_b128 v[204:207], v234 offset:3264
    v_mfma_f32_16x16x32_bf16 v[24:27], v[88:91], v[176:179], v[24:27]
    ds_read_b128 v[208:211], v234 offset:2752
    v_mfma_f32_16x16x32_bf16 v[28:31], v[92:95], v[176:179], v[28:31]
    ds_read_b128 v[212:215], v234 offset:2240
    s_waitcnt lgkmcnt(15)
    v_mfma_f32_16x16x32_bf16 v[20:23], v[80:83], v[180:183], v[20:23]
    ds_read_b128 v[216:219], v234 offset:1728
    v_mfma_f32_16x16x32_bf16 v[24:27], v[84:87], v[180:183], v[24:27]
    ds_read2_b32 v[144:145], v232 offset0:96 offset1:97
    v_mfma_f32_16x16x32_bf16 v[28:31], v[88:91], v[180:183], v[28:31]
    ds_read2_b32 v[146:147], v232 offset0:98 offset1:99
    v_mfma_f32_16x16x32_bf16 v[32:35], v[92:95], v[180:183], v[32:35]
    ds_read2_b32 v[148:149], v232 offset0:224 offset1:225
    s_waitcnt lgkmcnt(15)
    v_mfma_f32_16x16x32_bf16 v[24:27], v[80:83], v[184:187], v[24:27]
    ds_read2_b32 v[150:151], v232 offset0:226 offset1:227
    v_mfma_f32_16x16x32_bf16 v[28:31], v[84:87], v[184:187], v[28:31]
    ds_read2_b32 v[152:153], v233 offset0:96 offset1:97
    v_mfma_f32_16x16x32_bf16 v[32:35], v[88:91], v[184:187], v[32:35]
    ds_read2_b32 v[154:155], v233 offset0:98 offset1:99
    v_mfma_f32_16x16x32_bf16 v[28:31], v[80:83], v[188:191], v[28:31]
    ds_read2_b32 v[156:157], v233 offset0:224 offset1:225
    v_mfma_f32_16x16x32_bf16 v[32:35], v[84:87], v[188:191], v[32:35]
    ds_read2_b32 v[158:159], v233 offset0:226 offset1:227
    v_mfma_f32_16x16x32_bf16 v[32:35], v[80:83], v[192:195], v[32:35]
    s_waitcnt lgkmcnt(12)
    v_mfma_f32_16x16x32_bf16 v[16:19], v[96:99], v[200:203], v[16:19]
    ds_read_b128 v[176:179], v234 offset:3840
    v_mfma_f32_16x16x32_bf16 v[20:23], v[100:103], v[200:203], v[20:23]
    ds_read_b128 v[180:183], v234 offset:3328
    v_mfma_f32_16x16x32_bf16 v[24:27], v[104:107], v[200:203], v[24:27]
    ds_read_b128 v[184:187], v234 offset:2816
    v_mfma_f32_16x16x32_bf16 v[28:31], v[108:111], v[200:203], v[28:31]
    ds_read_b128 v[188:191], v234 offset:2304
    s_waitcnt lgkmcnt(15)
    v_mfma_f32_16x16x32_bf16 v[20:23], v[96:99], v[204:207], v[20:23]
    ds_read_b128 v[192:195], v234 offset:1792
    v_mfma_f32_16x16x32_bf16 v[24:27], v[100:103], v[204:207], v[24:27]
    ds_read2_b32 v[160:161], v232 offset0:112 offset1:113
    v_mfma_f32_16x16x32_bf16 v[28:31], v[104:107], v[204:207], v[28:31]
    ds_read2_b32 v[162:163], v232 offset0:114 offset1:115
    v_mfma_f32_16x16x32_bf16 v[32:35], v[108:111], v[204:207], v[32:35]
    ds_read2_b32 v[164:165], v232 offset0:240 offset1:241
    s_waitcnt lgkmcnt(15)
    v_mfma_f32_16x16x32_bf16 v[24:27], v[96:99], v[208:211], v[24:27]
    ds_read2_b32 v[166:167], v232 offset0:242 offset1:243
    v_mfma_f32_16x16x32_bf16 v[28:31], v[100:103], v[208:211], v[28:31]
    ds_read2_b32 v[168:169], v233 offset0:112 offset1:113
    v_mfma_f32_16x16x32_bf16 v[32:35], v[104:107], v[208:211], v[32:35]
    ds_read2_b32 v[170:171], v233 offset0:114 offset1:115
    v_mfma_f32_16x16x32_bf16 v[28:31], v[96:99], v[212:215], v[28:31]
    ds_read2_b32 v[172:173], v233 offset0:240 offset1:241
    v_mfma_f32_16x16x32_bf16 v[32:35], v[100:103], v[212:215], v[32:35]
    ds_read2_b32 v[174:175], v233 offset0:242 offset1:243
    v_mfma_f32_16x16x32_bf16 v[32:35], v[96:99], v[216:219], v[32:35]
    s_waitcnt lgkmcnt(12)
    v_mfma_f32_16x16x32_bf16 v[16:19], v[112:115], v[176:179], v[16:19]
    ds_read_b128 v[200:203], v234 offset:3904
    v_mfma_f32_16x16x32_bf16 v[20:23], v[116:119], v[176:179], v[20:23]
    ds_read_b128 v[204:207], v234 offset:3392
    v_mfma_f32_16x16x32_bf16 v[24:27], v[120:123], v[176:179], v[24:27]
    ds_read_b128 v[208:211], v234 offset:2880
    v_mfma_f32_16x16x32_bf16 v[28:31], v[124:127], v[176:179], v[28:31]
    ds_read_b128 v[212:215], v234 offset:2368
    s_waitcnt lgkmcnt(15)
    v_mfma_f32_16x16x32_bf16 v[20:23], v[112:115], v[180:183], v[20:23]
    ds_read_b128 v[216:219], v234 offset:1856
    v_mfma_f32_16x16x32_bf16 v[24:27], v[116:119], v[180:183], v[24:27]
    v_mfma_f32_16x16x32_bf16 v[28:31], v[120:123], v[180:183], v[28:31]
    v_mfma_f32_16x16x32_bf16 v[32:35], v[124:127], v[180:183], v[32:35]
    s_waitcnt lgkmcnt(15)
    v_mfma_f32_16x16x32_bf16 v[24:27], v[112:115], v[184:187], v[24:27]
    v_mfma_f32_16x16x32_bf16 v[28:31], v[116:119], v[184:187], v[28:31]
    v_mfma_f32_16x16x32_bf16 v[32:35], v[120:123], v[184:187], v[32:35]
    s_waitcnt lgkmcnt(14)
    v_mfma_f32_16x16x32_bf16 v[28:31], v[112:115], v[188:191], v[28:31]
    v_mfma_f32_16x16x32_bf16 v[32:35], v[116:119], v[188:191], v[32:35]
    s_waitcnt lgkmcnt(13)
    v_mfma_f32_16x16x32_bf16 v[32:35], v[112:115], v[192:195], v[32:35]
    s_waitcnt lgkmcnt(4)
    v_mfma_f32_16x16x32_bf16 v[16:19], v[128:131], v[200:203], v[16:19]
    ds_read_b128 v[176:179], v234 offset:3968
    v_mfma_f32_16x16x32_bf16 v[20:23], v[132:135], v[200:203], v[20:23]
    ds_read_b128 v[180:183], v234 offset:3456
    v_mfma_f32_16x16x32_bf16 v[24:27], v[136:139], v[200:203], v[24:27]
    ds_read_b128 v[184:187], v234 offset:2944
    v_mfma_f32_16x16x32_bf16 v[28:31], v[140:143], v[200:203], v[28:31]
    ds_read_b128 v[188:191], v234 offset:2432
    s_waitcnt lgkmcnt(7)
    v_mfma_f32_16x16x32_bf16 v[20:23], v[128:131], v[204:207], v[20:23]
    ds_read_b128 v[192:195], v234 offset:1920
    v_mfma_f32_16x16x32_bf16 v[24:27], v[132:135], v[204:207], v[24:27]
    v_mfma_f32_16x16x32_bf16 v[28:31], v[136:139], v[204:207], v[28:31]
    v_mfma_f32_16x16x32_bf16 v[32:35], v[140:143], v[204:207], v[32:35]
    s_waitcnt lgkmcnt(7)
    v_mfma_f32_16x16x32_bf16 v[24:27], v[128:131], v[208:211], v[24:27]
    v_mfma_f32_16x16x32_bf16 v[28:31], v[132:135], v[208:211], v[28:31]
    v_mfma_f32_16x16x32_bf16 v[32:35], v[136:139], v[208:211], v[32:35]
    s_waitcnt lgkmcnt(6)
    v_mfma_f32_16x16x32_bf16 v[28:31], v[128:131], v[212:215], v[28:31]
    v_mfma_f32_16x16x32_bf16 v[32:35], v[132:135], v[212:215], v[32:35]
    s_waitcnt lgkmcnt(5)
    v_mfma_f32_16x16x32_bf16 v[32:35], v[128:131], v[216:219], v[32:35]
    s_waitcnt lgkmcnt(4)
    v_mfma_f32_16x16x32_bf16 v[16:19], v[144:147], v[176:179], v[16:19]
    ds_read_b128 v[200:203], v234 offset:4032
    v_mfma_f32_16x16x32_bf16 v[20:23], v[148:151], v[176:179], v[20:23]
    ds_read_b128 v[204:207], v234 offset:3520
    v_mfma_f32_16x16x32_bf16 v[24:27], v[152:155], v[176:179], v[24:27]
    ds_read_b128 v[208:211], v234 offset:3008
    v_mfma_f32_16x16x32_bf16 v[28:31], v[156:159], v[176:179], v[28:31]
    ds_read_b128 v[212:215], v234 offset:2496
    s_waitcnt lgkmcnt(7)
    v_mfma_f32_16x16x32_bf16 v[20:23], v[144:147], v[180:183], v[20:23]
    ds_read_b128 v[216:219], v234 offset:1984
    v_mfma_f32_16x16x32_bf16 v[24:27], v[148:151], v[180:183], v[24:27]
    v_mfma_f32_16x16x32_bf16 v[28:31], v[152:155], v[180:183], v[28:31]
    v_mfma_f32_16x16x32_bf16 v[32:35], v[156:159], v[180:183], v[32:35]
    s_waitcnt lgkmcnt(7)
    v_mfma_f32_16x16x32_bf16 v[24:27], v[144:147], v[184:187], v[24:27]
    v_mfma_f32_16x16x32_bf16 v[28:31], v[148:151], v[184:187], v[28:31]
    v_mfma_f32_16x16x32_bf16 v[32:35], v[152:155], v[184:187], v[32:35]
    s_waitcnt lgkmcnt(6)
    v_mfma_f32_16x16x32_bf16 v[28:31], v[144:147], v[188:191], v[28:31]
    v_mfma_f32_16x16x32_bf16 v[32:35], v[148:151], v[188:191], v[32:35]
    s_waitcnt lgkmcnt(5)
    v_mfma_f32_16x16x32_bf16 v[32:35], v[144:147], v[192:195], v[32:35]
    s_waitcnt lgkmcnt(4)
    v_mfma_f32_16x16x32_bf16 v[16:19], v[160:163], v[200:203], v[16:19]
    ds_read_b128 v[176:179], v234 offset:2560
    v_mfma_f32_16x16x32_bf16 v[20:23], v[164:167], v[200:203], v[20:23]
    ds_read_b128 v[180:183], v234 offset:2048
    v_mfma_f32_16x16x32_bf16 v[24:27], v[168:171], v[200:203], v[24:27]
    ds_read_b128 v[184:187], v234 offset:1536
    v_mfma_f32_16x16x32_bf16 v[28:31], v[172:175], v[200:203], v[28:31]
    ds_read_b128 v[188:191], v234 offset:1024
    s_waitcnt lgkmcnt(7)
    v_mfma_f32_16x16x32_bf16 v[20:23], v[160:163], v[204:207], v[20:23]
    ds_read_b128 v[192:195], v234 offset:512
    v_mfma_f32_16x16x32_bf16 v[24:27], v[164:167], v[204:207], v[24:27]
    ds_read_b128 v[196:199], v234 offset:0
    v_mfma_f32_16x16x32_bf16 v[28:31], v[168:171], v[204:207], v[28:31]
    v_mfma_f32_16x16x32_bf16 v[32:35], v[172:175], v[204:207], v[32:35]
    s_waitcnt lgkmcnt(8)
    v_mfma_f32_16x16x32_bf16 v[24:27], v[160:163], v[208:211], v[24:27]
    s_barrier
    v_mfma_f32_16x16x32_bf16 v[28:31], v[164:167], v[208:211], v[28:31]
    ds_read_b128 v[4:7], v235 offset:4608
    v_mfma_f32_16x16x32_bf16 v[32:35], v[168:171], v[208:211], v[32:35]
    ds_read_b128 v[8:11], v235 offset:5632
    s_waitcnt lgkmcnt(9)
    v_mfma_f32_16x16x32_bf16 v[28:31], v[160:163], v[212:215], v[28:31]
    ds_read_b128 v[12:15], v235 offset:6656
    v_mfma_f32_16x16x32_bf16 v[32:35], v[164:167], v[212:215], v[32:35]
    ds_read_b128 v[228:231], v235 offset:7680
    s_waitcnt lgkmcnt(10)
    v_mfma_f32_16x16x32_bf16 v[32:35], v[160:163], v[216:219], v[32:35]
    ds_read_b128 v[240:243], v235 offset:8704
    s_waitcnt lgkmcnt(10)
    v_mfma_f32_16x16x32_bf16 v[36:39], v[60:63], v[176:179], 0
    ds_read_b128 v[200:203], v234 offset:2624
    s_waitcnt lgkmcnt(10)
    v_mfma_f32_16x16x32_bf16 v[36:39], v[56:59], v[180:183], v[36:39]
    ds_read_b128 v[204:207], v234 offset:2112
    v_mfma_f32_16x16x32_bf16 v[40:43], v[60:63], v[180:183], 0
    ds_read_b128 v[208:211], v234 offset:1600
    s_waitcnt lgkmcnt(11)
    v_mfma_f32_16x16x32_bf16 v[36:39], v[52:55], v[184:187], v[36:39]
    ds_read_b128 v[212:215], v234 offset:1088
    s_waitcnt lgkmcnt(8)
    v_pk_add_f32 v[16:17], v[16:17], v[4:5]
    v_mfma_f32_16x16x32_bf16 v[40:43], v[56:59], v[184:187], v[40:43]
    ds_read_b128 v[216:219], v234 offset:576
    v_pk_add_f32 v[18:19], v[18:19], v[6:7]
    v_mfma_f32_16x16x32_bf16 v[44:47], v[60:63], v[184:187], 0
    ds_read_b128 v[220:223], v234 offset:64
    v_cvt_pk_bf16_f32 v16, v16, v17
    v_mfma_f32_16x16x32_bf16 v[36:39], v[48:51], v[188:191], v[36:39]
    v_cvt_pk_bf16_f32 v17, v18, v19
    s_waitcnt lgkmcnt(9)
    v_pk_add_f32 v[20:21], v[20:21], v[8:9]
    v_mfma_f32_16x16x32_bf16 v[40:43], v[52:55], v[188:191], v[40:43]
    v_pk_add_f32 v[22:23], v[22:23], v[10:11]
    v_cvt_pk_bf16_f32 v18, v20, v21
    v_mfma_f32_16x16x32_bf16 v[44:47], v[56:59], v[188:191], v[44:47]
    v_cvt_pk_bf16_f32 v19, v22, v23
    s_nop 1
    v_mfma_f32_16x16x32_bf16 v[40:43], v[48:51], v[192:195], v[40:43]
    v_permlane16_swap_b32 v16, v18
    v_permlane16_swap_b32 v17, v19
    v_mfma_f32_16x16x32_bf16 v[44:47], v[52:55], v[192:195], v[44:47]
    buffer_store_dwordx4 v[16:19], v237, s[12:15], s47 offen offset:0 sc1
    s_waitcnt lgkmcnt(8)
    v_pk_add_f32 v[24:25], v[24:25], v[12:13]
    v_mfma_f32_16x16x32_bf16 v[44:47], v[48:51], v[196:199], v[44:47]
    v_pk_add_f32 v[26:27], v[26:27], v[14:15]
    v_cvt_pk_bf16_f32 v24, v24, v25
    s_waitcnt lgkmcnt(5)
    v_mfma_f32_16x16x32_bf16 v[36:39], v[76:79], v[200:203], v[36:39]
    ds_read_b128 v[176:179], v234 offset:2688
    v_cvt_pk_bf16_f32 v25, v26, v27
    s_waitcnt lgkmcnt(5)
    v_mfma_f32_16x16x32_bf16 v[36:39], v[72:75], v[204:207], v[36:39]
    ds_read_b128 v[180:183], v234 offset:2176
    v_pk_add_f32 v[28:29], v[28:29], v[228:229]
    v_mfma_f32_16x16x32_bf16 v[40:43], v[76:79], v[204:207], v[40:43]
    ds_read_b128 v[184:187], v234 offset:1664
    v_pk_add_f32 v[30:31], v[30:31], v[230:231]
    s_waitcnt lgkmcnt(6)
    v_mfma_f32_16x16x32_bf16 v[36:39], v[68:71], v[208:211], v[36:39]
    ds_read_b128 v[188:191], v234 offset:1152
    v_cvt_pk_bf16_f32 v26, v28, v29
    v_mfma_f32_16x16x32_bf16 v[40:43], v[72:75], v[208:211], v[40:43]
    ds_read_b128 v[192:195], v234 offset:640
    v_cvt_pk_bf16_f32 v27, v30, v31
    v_mfma_f32_16x16x32_bf16 v[44:47], v[76:79], v[208:211], v[44:47]
    ds_read_b128 v[196:199], v234 offset:128
    s_nop 1
    s_waitcnt lgkmcnt(8)
    v_mfma_f32_16x16x32_bf16 v[36:39], v[64:67], v[212:215], v[36:39]
    v_permlane16_swap_b32 v24, v26
    v_permlane16_swap_b32 v25, v27
    v_mfma_f32_16x16x32_bf16 v[40:43], v[68:71], v[212:215], v[40:43]
    buffer_store_dwordx4 v[24:27], v237, s[12:15], s47 offen offset:1024 sc1
    v_pk_add_f32 v[32:33], v[32:33], v[240:241]
    v_mfma_f32_16x16x32_bf16 v[44:47], v[72:75], v[212:215], v[44:47]
    v_pk_add_f32 v[34:35], v[34:35], v[242:243]
    v_cvt_pk_bf16_f32 v32, v32, v33
    s_waitcnt lgkmcnt(7)
    v_mfma_f32_16x16x32_bf16 v[40:43], v[64:67], v[216:219], v[40:43]
    v_cvt_pk_bf16_f32 v33, v34, v35
    buffer_store_dwordx2 v[32:33], v238, s[12:15], s47 offen offset:2048 sc1
    v_mfma_f32_16x16x32_bf16 v[44:47], v[68:71], v[216:219], v[44:47]
    s_waitcnt lgkmcnt(6)
    v_mfma_f32_16x16x32_bf16 v[44:47], v[64:67], v[220:223], v[44:47]
    s_waitcnt lgkmcnt(5)
    v_mfma_f32_16x16x32_bf16 v[36:39], v[92:95], v[176:179], v[36:39]
    ds_read_b128 v[200:203], v234 offset:2752
    s_waitcnt lgkmcnt(5)
    v_mfma_f32_16x16x32_bf16 v[36:39], v[88:91], v[180:183], v[36:39]
    ds_read_b128 v[204:207], v234 offset:2240
    v_mfma_f32_16x16x32_bf16 v[40:43], v[92:95], v[180:183], v[40:43]
    ds_read_b128 v[208:211], v234 offset:1728
    s_waitcnt lgkmcnt(6)
    v_mfma_f32_16x16x32_bf16 v[36:39], v[84:87], v[184:187], v[36:39]
    ds_read_b128 v[212:215], v234 offset:1216
    v_mfma_f32_16x16x32_bf16 v[40:43], v[88:91], v[184:187], v[40:43]
    ds_read_b128 v[216:219], v234 offset:704
    v_mfma_f32_16x16x32_bf16 v[44:47], v[92:95], v[184:187], v[44:47]
    ds_read_b128 v[220:223], v234 offset:192
    s_waitcnt lgkmcnt(8)
    v_mfma_f32_16x16x32_bf16 v[36:39], v[80:83], v[188:191], v[36:39]
    v_mfma_f32_16x16x32_bf16 v[40:43], v[84:87], v[188:191], v[40:43]
    v_mfma_f32_16x16x32_bf16 v[44:47], v[88:91], v[188:191], v[44:47]
    s_waitcnt lgkmcnt(7)
    v_mfma_f32_16x16x32_bf16 v[40:43], v[80:83], v[192:195], v[40:43]
    v_mfma_f32_16x16x32_bf16 v[44:47], v[84:87], v[192:195], v[44:47]
    s_waitcnt lgkmcnt(6)
    v_mfma_f32_16x16x32_bf16 v[44:47], v[80:83], v[196:199], v[44:47]
    s_waitcnt lgkmcnt(5)
    v_mfma_f32_16x16x32_bf16 v[36:39], v[108:111], v[200:203], v[36:39]
    ds_read_b128 v[176:179], v234 offset:2816
    s_waitcnt lgkmcnt(5)
    v_mfma_f32_16x16x32_bf16 v[36:39], v[104:107], v[204:207], v[36:39]
    ds_read_b128 v[180:183], v234 offset:2304
    v_mfma_f32_16x16x32_bf16 v[40:43], v[108:111], v[204:207], v[40:43]
    ds_read_b128 v[184:187], v234 offset:1792
    s_waitcnt lgkmcnt(6)
    v_mfma_f32_16x16x32_bf16 v[36:39], v[100:103], v[208:211], v[36:39]
    ds_read_b128 v[188:191], v234 offset:1280
    v_mfma_f32_16x16x32_bf16 v[40:43], v[104:107], v[208:211], v[40:43]
    ds_read_b128 v[192:195], v234 offset:768
    v_mfma_f32_16x16x32_bf16 v[44:47], v[108:111], v[208:211], v[44:47]
    ds_read_b128 v[196:199], v234 offset:256
    s_waitcnt lgkmcnt(8)
    v_mfma_f32_16x16x32_bf16 v[36:39], v[96:99], v[212:215], v[36:39]
    ds_read_b128 v[64:67], v234 offset:3600
    v_mfma_f32_16x16x32_bf16 v[40:43], v[100:103], v[212:215], v[40:43]
    ds_read_b128 v[68:71], v234 offset:3088
    v_mfma_f32_16x16x32_bf16 v[44:47], v[104:107], v[212:215], v[44:47]
    ds_read_b128 v[72:75], v234 offset:2576
    s_waitcnt lgkmcnt(10)
    v_mfma_f32_16x16x32_bf16 v[40:43], v[96:99], v[216:219], v[40:43]
    ds_read_b128 v[76:79], v234 offset:2064
    v_mfma_f32_16x16x32_bf16 v[44:47], v[100:103], v[216:219], v[44:47]
    s_waitcnt lgkmcnt(10)
    v_mfma_f32_16x16x32_bf16 v[44:47], v[96:99], v[220:223], v[44:47]
    s_waitcnt lgkmcnt(9)
    v_mfma_f32_16x16x32_bf16 v[36:39], v[124:127], v[176:179], v[36:39]
    ds_read_b128 v[200:203], v234 offset:2880
    s_waitcnt lgkmcnt(9)
    v_mfma_f32_16x16x32_bf16 v[36:39], v[120:123], v[180:183], v[36:39]
    ds_read_b128 v[204:207], v234 offset:2368
    v_mfma_f32_16x16x32_bf16 v[40:43], v[124:127], v[180:183], v[40:43]
    ds_read_b128 v[208:211], v234 offset:1856
    s_waitcnt lgkmcnt(10)
    v_mfma_f32_16x16x32_bf16 v[36:39], v[116:119], v[184:187], v[36:39]
    ds_read_b128 v[212:215], v234 offset:1344
    v_mfma_f32_16x16x32_bf16 v[40:43], v[120:123], v[184:187], v[40:43]
    ds_read_b128 v[216:219], v234 offset:832
    v_mfma_f32_16x16x32_bf16 v[44:47], v[124:127], v[184:187], v[44:47]
    ds_read_b128 v[220:223], v234 offset:320
    s_waitcnt lgkmcnt(12)
    v_mfma_f32_16x16x32_bf16 v[36:39], v[112:115], v[188:191], v[36:39]
    ds_read_b128 v[48:51], v234 offset:3584
    v_mfma_f32_16x16x32_bf16 v[40:43], v[116:119], v[188:191], v[40:43]
    ds_read_b128 v[52:55], v234 offset:3072
    v_mfma_f32_16x16x32_bf16 v[44:47], v[120:123], v[188:191], v[44:47]
    ds_read_b128 v[56:59], v234 offset:2560
    s_waitcnt lgkmcnt(14)
    v_mfma_f32_16x16x32_bf16 v[40:43], v[112:115], v[192:195], v[40:43]
    ds_read_b128 v[60:63], v234 offset:2048
    v_mfma_f32_16x16x32_bf16 v[44:47], v[116:119], v[192:195], v[44:47]
    s_waitcnt lgkmcnt(14)
    v_mfma_f32_16x16x32_bf16 v[44:47], v[112:115], v[196:199], v[44:47]
    s_waitcnt vmcnt(0)
    s_barrier
    s_waitcnt lgkmcnt(9)
    v_mfma_f32_16x16x32_bf16 v[36:39], v[140:143], v[200:203], v[36:39]
    ds_read_b128 v[176:179], v234 offset:2944
    s_waitcnt lgkmcnt(9)
    v_mfma_f32_16x16x32_bf16 v[36:39], v[136:139], v[204:207], v[36:39]
    ds_read_b128 v[180:183], v234 offset:2432
    v_mfma_f32_16x16x32_bf16 v[40:43], v[140:143], v[204:207], v[40:43]
    ds_read_b128 v[184:187], v234 offset:1920
    s_waitcnt lgkmcnt(10)
    v_mfma_f32_16x16x32_bf16 v[36:39], v[132:135], v[208:211], v[36:39]
    ds_read_b128 v[188:191], v234 offset:1408
    v_mfma_f32_16x16x32_bf16 v[40:43], v[136:139], v[208:211], v[40:43]
    ds_read_b128 v[192:195], v234 offset:896
    v_mfma_f32_16x16x32_bf16 v[44:47], v[140:143], v[208:211], v[44:47]
    ds_read_b128 v[196:199], v234 offset:384
    s_waitcnt lgkmcnt(12)
    v_mfma_f32_16x16x32_bf16 v[36:39], v[128:131], v[212:215], v[36:39]
    ds_read2_b32 v[80:81], v236 offset0:24 offset1:25
    ds_read2_b32 v[82:83], v236 offset0:32 offset1:33
    v_mfma_f32_16x16x32_bf16 v[40:43], v[132:135], v[212:215], v[40:43]
    ds_read2_b32 v[84:85], v236 offset0:16 offset1:17
    ds_read2_b32 v[86:87], v236 offset0:24 offset1:25
    v_mfma_f32_16x16x32_bf16 v[44:47], v[136:139], v[212:215], v[44:47]
    ds_read2_b32 v[88:89], v236 offset0:8 offset1:9
    ds_read2_b32 v[90:91], v236 offset0:16 offset1:17
    s_waitcnt lgkmcnt(15)
    v_mfma_f32_16x16x32_bf16 v[40:43], v[128:131], v[216:219], v[40:43]
    ds_read2_b32 v[92:93], v236 offset0:0 offset1:1
    ds_read2_b32 v[94:95], v236 offset0:8 offset1:9
    v_mfma_f32_16x16x32_bf16 v[44:47], v[132:135], v[216:219], v[44:47]
    v_mfma_f32_16x16x32_bf16 v[44:47], v[128:131], v[220:223], v[44:47]
    v_mfma_f32_16x16x32_bf16 v[112:115], v[48:51], v[244:247], 0
    ds_read_b128 v[200:203], v234 offset:3008
    s_waitcnt lgkmcnt(15)
    v_mfma_f32_16x16x32_bf16 v[116:119], v[52:55], v[244:247], 0
    ds_read_b128 v[204:207], v234 offset:2496
    v_mfma_f32_16x16x32_bf16 v[120:123], v[56:59], v[244:247], 0
    ds_read_b128 v[208:211], v234 offset:1984
    v_mfma_f32_16x16x32_bf16 v[124:127], v[60:63], v[244:247], 0
    ds_read_b128 v[212:215], v234 offset:1472
    v_mfma_f32_16x16x32_bf16 v[128:131], v[64:67], v[248:251], 0
    ds_read_b128 v[216:219], v234 offset:960
    v_mfma_f32_16x16x32_bf16 v[132:135], v[68:71], v[248:251], 0
    ds_read_b128 v[220:223], v234 offset:448
    v_mfma_f32_16x16x32_bf16 v[136:139], v[72:75], v[248:251], 0
    ds_read2_b32 v[96:97], v236 offset0:184 offset1:185
    ds_read2_b32 v[98:99], v236 offset0:192 offset1:193
    v_mfma_f32_16x16x32_bf16 v[140:143], v[76:79], v[248:251], 0
    ds_read2_b32 v[100:101], v236 offset0:176 offset1:177
    ds_read2_b32 v[102:103], v236 offset0:184 offset1:185
    v_mfma_f32_16x16x32_bf16 v[36:39], v[224:227], v[52:55], v[36:39]
    ds_read2_b32 v[104:105], v236 offset0:168 offset1:169
    ds_read2_b32 v[106:107], v236 offset0:176 offset1:177
    v_mfma_f32_16x16x32_bf16 v[40:43], v[224:227], v[56:59], v[40:43]
    ds_read2_b32 v[108:109], v236 offset0:160 offset1:161
    ds_read2_b32 v[110:111], v236 offset0:168 offset1:169
    v_mfma_f32_16x16x32_bf16 v[44:47], v[224:227], v[60:63], v[44:47]
    ds_read_b128 v[4:7], v235 offset:9728
    s_waitcnt lgkmcnt(15)
    v_mfma_f32_16x16x32_bf16 v[36:39], v[156:159], v[176:179], v[36:39]
    ds_read_b128 v[8:11], v235 offset:10752
    v_mfma_f32_16x16x32_bf16 v[36:39], v[152:155], v[180:183], v[36:39]
    ds_read_b128 v[12:15], v235 offset:11776
    v_mfma_f32_16x16x32_bf16 v[40:43], v[156:159], v[180:183], v[40:43]
    v_mfma_f32_16x16x32_bf16 v[36:39], v[148:151], v[184:187], v[36:39]
    v_cvt_pk_bf16_f32 v16, v112, v113
    v_cvt_pk_bf16_f32 v17, v114, v115
    v_mfma_f32_16x16x32_bf16 v[40:43], v[152:155], v[184:187], v[40:43]
    v_cvt_pk_bf16_f32 v18, v116, v117
    v_cvt_pk_bf16_f32 v19, v118, v119
    v_mfma_f32_16x16x32_bf16 v[44:47], v[156:159], v[184:187], v[44:47]
    v_cvt_pk_bf16_f32 v20, v120, v121
    v_cvt_pk_bf16_f32 v21, v122, v123
    v_mfma_f32_16x16x32_bf16 v[36:39], v[144:147], v[188:191], v[36:39]
    v_cvt_pk_bf16_f32 v22, v124, v125
    v_cvt_pk_bf16_f32 v23, v126, v127
    v_mfma_f32_16x16x32_bf16 v[40:43], v[148:151], v[188:191], v[40:43]
    v_cvt_pk_bf16_f32 v24, v128, v129
    v_cvt_pk_bf16_f32 v25, v130, v131
    v_mfma_f32_16x16x32_bf16 v[44:47], v[152:155], v[188:191], v[44:47]
    v_cvt_pk_bf16_f32 v26, v132, v133
    v_cvt_pk_bf16_f32 v27, v134, v135
    v_mfma_f32_16x16x32_bf16 v[40:43], v[144:147], v[192:195], v[40:43]
    v_cvt_pk_bf16_f32 v28, v136, v137
    v_cvt_pk_bf16_f32 v29, v138, v139
    v_mfma_f32_16x16x32_bf16 v[44:47], v[148:151], v[192:195], v[44:47]
    v_cvt_pk_bf16_f32 v30, v140, v141
    v_cvt_pk_bf16_f32 v31, v142, v143
    v_mfma_f32_16x16x32_bf16 v[44:47], v[144:147], v[196:199], v[44:47]
    s_waitcnt lgkmcnt(15)
    v_mfma_f32_16x16x32_bf16 v[36:39], v[172:175], v[200:203], v[36:39]
    v_mfma_f32_16x16x32_bf16 v[36:39], v[168:171], v[204:207], v[36:39]
    s_waitcnt lgkmcnt(14)
    v_mfma_f32_16x16x32_bf16 v[36:39], v[164:167], v[208:211], v[36:39]
    s_waitcnt lgkmcnt(13)
    v_mfma_f32_16x16x32_bf16 v[36:39], v[160:163], v[212:215], v[36:39]
    v_mfma_f32_16x16x32_bf16 v[36:39], v[16:19], v[84:87], v[36:39]
    s_waitcnt lgkmcnt(7)
    v_mfma_f32_16x16x32_bf16 v[36:39], v[24:27], v[100:103], v[36:39]
    v_mfma_f32_16x16x32_bf16 v[40:43], v[172:175], v[204:207], v[40:43]
    v_mfma_f32_16x16x32_bf16 v[40:43], v[168:171], v[208:211], v[40:43]
    v_mfma_f32_16x16x32_bf16 v[40:43], v[164:167], v[212:215], v[40:43]
    v_mfma_f32_16x16x32_bf16 v[40:43], v[160:163], v[216:219], v[40:43]
    v_mfma_f32_16x16x32_bf16 v[40:43], v[16:19], v[88:91], v[40:43]
    v_mfma_f32_16x16x32_bf16 v[40:43], v[20:23], v[80:83], v[40:43]
    s_waitcnt lgkmcnt(5)
    v_mfma_f32_16x16x32_bf16 v[40:43], v[24:27], v[104:107], v[40:43]
    v_mfma_f32_16x16x32_bf16 v[40:43], v[28:31], v[96:99], v[40:43]
    v_mfma_f32_16x16x32_bf16 v[44:47], v[172:175], v[208:211], v[44:47]
    s_waitcnt lgkmcnt(2)
    v_pk_add_f32 v[36:37], v[36:37], v[4:5]
    v_mfma_f32_16x16x32_bf16 v[44:47], v[168:171], v[212:215], v[44:47]
    v_pk_add_f32 v[38:39], v[38:39], v[6:7]
    v_mfma_f32_16x16x32_bf16 v[44:47], v[164:167], v[216:219], v[44:47]
    v_cvt_pk_bf16_f32 v36, v36, v37
    v_mfma_f32_16x16x32_bf16 v[44:47], v[160:163], v[220:223], v[44:47]
    v_cvt_pk_bf16_f32 v37, v38, v39
    v_mfma_f32_16x16x32_bf16 v[44:47], v[16:19], v[92:95], v[44:47]
    buffer_store_dwordx2 v[36:37], v238, s[12:15], s47 offen offset:2560 sc1
    v_mfma_f32_16x16x32_bf16 v[44:47], v[20:23], v[84:87], v[44:47]
    v_mfma_f32_16x16x32_bf16 v[44:47], v[24:27], v[108:111], v[44:47]
    v_mfma_f32_16x16x32_bf16 v[44:47], v[28:31], v[100:103], v[44:47]
    s_waitcnt lgkmcnt(1)
    v_pk_add_f32 v[40:41], v[40:41], v[8:9]
    v_pk_add_f32 v[42:43], v[42:43], v[10:11]
    v_cvt_pk_bf16_f32 v40, v40, v41
    v_cvt_pk_bf16_f32 v41, v42, v43
    s_nop 3
    s_waitcnt lgkmcnt(0)
    v_pk_add_f32 v[44:45], v[44:45], v[12:13]
    v_pk_add_f32 v[46:47], v[46:47], v[14:15]
    v_cvt_pk_bf16_f32 v42, v44, v45
    v_cvt_pk_bf16_f32 v43, v46, v47
    s_nop 1
    v_permlane16_swap_b32 v40, v42
    v_permlane16_swap_b32 v41, v43
    buffer_store_dwordx4 v[40:43], v237, s[12:15], s47 offen offset:3072 sc1
    s_branch K2_COMP
K1_PREP:
    v_mov_b32 v5, 0
    s_sub_u32 s3, s2, 160
    s_lshl_b32 s46, s3, 2
    s_add_u32 s46, s46, s4
    s_add_u32 s46, s46, 520
    s_add_u32 s47, s46, 24
    s_cmp_eq_u32 s61, 0
    s_cselect_b32 s46, s47, s46
    s_add_u32 s47, s46, 0
    s_lshr_b32 s42, s47, 8
    s_lshl_b32 s42, s42, 9
    s_bfe_u32 s43, s47, 0x40002
    s_lshl_b32 s43, s43, 5
    s_add_u32 s42, s42, s43
    s_bfe_u32 s43, s47, 0x20006
    s_lshl_b32 s43, s43, 1
    s_add_u32 s42, s42, s43
    s_and_b32 s43, s47, 3
    s_lshl_b32 s43, s43, 3
    s_add_u32 s42, s42, s43
    v_lshrrev_b32 v7, 5, v1
    v_add_u32 v7, s42, v7
    v_mul_u32_u24 v7, 1280, v7
    v_and_b32 v13, 31, v1
    v_lshl_add_u32 v12, v13, 4, v7
    v_lshl_add_u32 v13, v13, 3, v7
    s_add_u32 s47, s46, 48
    s_lshr_b32 s42, s47, 8
    s_lshl_b32 s42, s42, 9
    s_bfe_u32 s43, s47, 0x40002
    s_lshl_b32 s43, s43, 5
    s_add_u32 s42, s42, s43
    s_bfe_u32 s43, s47, 0x20006
    s_lshl_b32 s43, s43, 1
    s_add_u32 s42, s42, s43
    s_and_b32 s43, s47, 3
    s_lshl_b32 s43, s43, 3
    s_add_u32 s42, s42, s43
    v_lshrrev_b32 v7, 5, v1
    v_add_u32 v7, s42, v7
    v_mul_u32_u24 v7, 1280, v7
    v_and_b32 v15, 31, v1
    v_lshl_add_u32 v14, v15, 4, v7
    v_lshl_add_u32 v15, v15, 3, v7
    s_add_u32 s47, s46, 96
    s_lshr_b32 s42, s47, 8
    s_lshl_b32 s42, s42, 9
    s_bfe_u32 s43, s47, 0x40002
    s_lshl_b32 s43, s43, 5
    s_add_u32 s42, s42, s43
    s_bfe_u32 s43, s47, 0x20006
    s_lshl_b32 s43, s43, 1
    s_add_u32 s42, s42, s43
    s_and_b32 s43, s47, 3
    s_lshl_b32 s43, s43, 3
    s_add_u32 s42, s42, s43
    v_lshrrev_b32 v7, 5, v1
    v_add_u32 v7, s42, v7
    v_mul_u32_u24 v7, 1280, v7
    v_and_b32 v17, 31, v1
    v_lshl_add_u32 v16, v17, 4, v7
    v_lshl_add_u32 v17, v17, 3, v7
    s_waitcnt lgkmcnt(0)
    s_load_dword s54, s[6:7], 0
    s_mov_b32 s12, s6
    s_mov_b32 s13, s7
    s_mov_b32 s14, 0x1900000
    s_mov_b32 s15, 0x00020000
    s_cmp_lt_u32 s3, 90
    s_cbranch_scc0 K1_ST
    s_cmp_eq_u32 s61, 0
    s_cbranch_scc1 K1_PREPW
    s_waitcnt lgkmcnt(0)
    s_add_u32 s53, s54, 0x9e3779b9
    s_branch K1_PH
K1_ST:
    s_lshl_b32 s47, s61, 8
    s_add_u32 s47, s47, s3
    s_cmp_lt_u32 s47, 90
    s_cbranch_scc1 K1_PREPD
    global_load_dwordx4 v[48:51], v12, s[16:17]
    global_load_dwordx4 v[52:55], v12, s[16:17] offset:512
    global_load_dwordx2 v[56:57], v13, s[16:17] offset:1024
    global_load_dwordx4 v[64:67], v14, s[16:17]
    global_load_dwordx4 v[68:71], v14, s[16:17] offset:512
    global_load_dwordx2 v[72:73], v15, s[16:17] offset:1024
    global_load_dwordx4 v[74:77], v16, s[16:17]
    global_load_dwordx4 v[78:81], v16, s[16:17] offset:512
    global_load_dwordx2 v[82:83], v17, s[16:17] offset:1024
    s_barrier
    s_mov_b32 s45, 3
    s_lshl_b32 s46, s46, 4
    s_add_u32 s46, s46, 0x1000
    s_waitcnt vmcnt(0) lgkmcnt(0)
    s_add_u32 s53, s54, 0x9e3779b9
K1_ST1:
    v_mov_b32 v60, 0
    v_mov_b32 v61, 0
    v_mov_b32 v62, 0x3f803f80
    v_lshrrev_b32 v63, 5, v1
    v_lshlrev_b32 v63, 3, v63
    v_dot2c_f32_bf16 v60, v62, v48
    v_dot2c_f32_bf16 v61, v48, v48
    v_dot2c_f32_bf16 v60, v62, v49
    v_dot2c_f32_bf16 v61, v49, v49
    v_dot2c_f32_bf16 v60, v62, v50
    v_dot2c_f32_bf16 v61, v50, v50
    v_dot2c_f32_bf16 v60, v62, v51
    v_dot2c_f32_bf16 v61, v51, v51
    v_dot2c_f32_bf16 v60, v62, v52
    v_dot2c_f32_bf16 v61, v52, v52
    v_dot2c_f32_bf16 v60, v62, v53
    v_dot2c_f32_bf16 v61, v53, v53
    v_dot2c_f32_bf16 v60, v62, v54
    v_dot2c_f32_bf16 v61, v54, v54
    v_dot2c_f32_bf16 v60, v62, v55
    v_dot2c_f32_bf16 v61, v55, v55
    v_dot2c_f32_bf16 v60, v62, v56
    v_dot2c_f32_bf16 v61, v56, v56
    v_dot2c_f32_bf16 v60, v62, v57
    v_dot2c_f32_bf16 v61, v57, v57
    s_nop 2
    v_add_f32_dpp v60, v60, v60 row_ror:8 row_mask:0xf bank_mask:0xf
    v_add_f32_dpp v61, v61, v61 row_ror:8 row_mask:0xf bank_mask:0xf
    s_nop 0
    v_add_f32_dpp v60, v60, v60 row_ror:4 row_mask:0xf bank_mask:0xf
    v_add_f32_dpp v61, v61, v61 row_ror:4 row_mask:0xf bank_mask:0xf
    s_nop 0
    v_add_f32_dpp v60, v60, v60 row_ror:2 row_mask:0xf bank_mask:0xf
    v_add_f32_dpp v61, v61, v61 row_ror:2 row_mask:0xf bank_mask:0xf
    s_nop 0
    v_add_f32_dpp v60, v60, v60 row_ror:1 row_mask:0xf bank_mask:0xf
    v_add_f32_dpp v61, v61, v61 row_ror:1 row_mask:0xf bank_mask:0xf
    s_nop 0
    v_mov_b32 v58, v60
    v_mov_b32 v59, v61
    s_nop 1
    v_permlane16_swap_b32 v60, v58
    v_permlane16_swap_b32 v61, v59
    s_nop 0
    v_pk_add_f32 v[60:61], v[60:61], v[58:59]
    v_mul_f32 v60, 0x3acccccd, v60
    v_mul_f32 v61, 0x3acccccd, v61
    v_fma_f32 v61, -v60, v60, v61
    v_max_f32 v61, 0, v61
    v_cvt_pk_bf16_f32 v61, v61, v61
    v_lshlrev_b32 v61, 16, v61
    v_add_f32 v61, 0x3727c5ac, v61
    v_cvt_pk_bf16_f32 v61, v61, v61
    v_lshlrev_b32 v61, 16, v61
    v_sqrt_f32 v61, v61
    s_nop 0
    v_cvt_pk_bf16_f32 v60, v60, v61
    v_mov_b32 v61, s53
    s_mov_b32 exec_lo, 1
    s_mov_b32 exec_hi, 1
    buffer_store_dwordx2 v[60:61], v63, s[12:15], s46 offen sc1
    s_mov_b64 exec, -1
    v_mov_b64 v[48:49], v[64:65]
    v_mov_b64 v[50:51], v[66:67]
    v_mov_b64 v[52:53], v[68:69]
    v_mov_b64 v[54:55], v[70:71]
    v_mov_b64 v[56:57], v[72:73]
    v_mov_b64 v[64:65], v[74:75]
    v_mov_b64 v[66:67], v[76:77]
    v_mov_b64 v[68:69], v[78:79]
    v_mov_b64 v[70:71], v[80:81]
    v_mov_b64 v[72:73], v[82:83]
    s_add_u32 s46, s46, 768
    s_sub_u32 s45, s45, 1
    s_cmp_lg_u32 s45, 0
    s_cbranch_scc1 K1_ST1
    s_barrier
    s_cmp_eq_u32 s61, 0
    s_cbranch_scc0 K1_PH
    s_barrier
    s_branch K2_COMPP
K1_PH:
    s_barrier
    s_mov_b32 s54, s53
    v_and_b32 v14, 31, v1
    v_lshlrev_b32 v14, 2, v14
    v_mov_b32 v15, s54
    s_lshl_b32 s3, s2, 7
    s_add_u32 s3, s3, 0x1860000
    s_cmp_lg_u32 s4, 0
    s_barrier
    s_cbranch_scc1 K1_WD2
    s_mov_b32 exec_hi, 0
    buffer_store_dword v15, v14, s[12:15], s3 offen sc1
    s_mov_b32 exec_hi, -1
K1_WD2:
    s_cmp_lt_u32 s2, 214
    s_cbranch_scc1 K2_LSETUP
    s_lshl_b32 s3, s2, 7
    s_add_u32 s3, s3, 0x186b000
    v_mov_b32 v5, s3
    s_mov_b32 s52, 0
K1_PHR1:
    buffer_load_dword v6, v5, s[12:15], 0 offen sc1
    s_add_u32 s52, s52, 1
    s_waitcnt vmcnt(0)
    v_cmp_ne_u32 vcc, s54, v6
    s_cmp_lt_u32 s52, 0x40000
    s_cbranch_vccz K1_PHR1_D
    s_mov_b64 exec, vcc
    s_sleep 8
    s_cbranch_scc1 K1_PHR1
K1_PHR1_D:
    s_mov_b64 exec, -1
    s_branch K2_LSETUP
K1_PREPW:
    s_cmp_ge_u32 s3, 54
    s_cbranch_scc1 K1_PREPD
    s_cmp_ge_u32 s3, 27
    s_cselect_b32 s40, 1, 0
    s_cselect_b32 s8, s38, s36
    s_cselect_b32 s9, s39, s37
    s_mul_i32 s41, s40, 27
    s_sub_u32 s41, s3, s41
    s_mov_b32 s10, 2211840
    s_mov_b32 s11, 0x00020000
    v_lshrrev_b32 v2, 3, v1
    v_and_b32 v3, 7, v1
    v_and_b32 v4, 6, v2
    v_xor_b32 v3, v3, v4
    v_mul_u32_u24 v2, 3456, v2
    v_lshl_add_u32 v2, v3, 4, v2
    s_lshl_b32 s42, s41, 7
    s_mul_i32 s43, s4, 552960
    s_add_u32 s42, s42, s43
    s_mul_i32 s44, s4, 20480
    s_mov_b32 s45, 0
K1_PW_LD:
    s_mov_b32 m0, s44
    s_add_u32 s44, s44, 1024
    s_add_u32 s45, s45, 1
    buffer_load_dwordx4 v2, s[8:11], s42 offen nt lds
    s_add_u32 s42, s42, 27648
    s_cmp_lt_u32 s45, 20
    s_cbranch_scc1 K1_PW_LD
    v_lshrrev_b32 v2, 2, v1
    v_and_b32 v3, 6, v2
    v_bfe_u32 v4, v1, 1, 1
    s_lshl_b32 s43, s4, 1
    v_add_u32 v4, s43, v4
    v_xor_b32 v3, v3, v4
    v_lshlrev_b32 v2, 7, v2
    v_lshl_add_u32 v2, v3, 4, v2
    v_and_b32 v3, 1, v1
    v_lshl_add_u32 v2, v3, 3, v2
    v_add_u32 v4, 40960, v2
    s_lshl_b32 s43, s41, 2
    s_add_u32 s43, s43, s4
    s_mul_i32 s44, s43, 9363
    s_lshr_b32 s44, s44, 16
    s_mul_i32 s45, s44, 7
    s_sub_u32 s45, s43, s45
    s_mul_i32 s46, s44, 286720
    s_add_u32 s46, s46, 0x290000
    s_cmp_gt_u32 s45, 3
    s_cselect_b32 s47, 3, 0
    s_add_u32 s47, s47, s45
    s_mul_i32 s48, s40, 3
    s_add_u32 s47, s47, s48
    s_lshl_b32 s47, s47, 10
    v_bfe_u32 v6, v1, 2, 1
    v_bfe_u32 v7, v1, 3, 1
    v_xor_b32 v6, v6, v7
    v_mul_u32_u24 v6, 12, v6
    s_and_b32 s48, s45, 3
    s_cmp_eq_u32 s48, 2
    s_cselect_b32 s48, -1, 0
    v_and_b32 v6, s48, v6
    v_xor_b32 v5, v6, v1
    v_lshlrev_b32 v5, 4, v5
    v_add_u32 v5, s47, v5
    v_and_b32 v6, 7, v1
    v_and_b32 v7, 48, v1
    v_add_u32 v6, v6, v7
    s_lshl_b32 s48, s40, 3
    v_add_u32 v6, s48, v6
    v_lshlrev_b32 v6, 4, v6
    v_bfe_u32 v7, v1, 3, 1
    v_mul_u32_u24 v7, 7168, v7
    v_add3_u32 v6, v6, v7, 0
    v_add_u32 v6, 6144, v6
    s_cmp_eq_u32 s45, 3
    s_cselect_b64 vcc, -1, 0
    s_nop 1
    v_cndmask_b32 v5, v5, v6, vcc
    s_waitcnt vmcnt(0)
    s_barrier
    ds_read_b64_tr_b16 v[16:17], v2 offset:0
    ds_read_b64_tr_b16 v[18:19], v2 offset:2048
    ds_read_b64_tr_b16 v[20:21], v2 offset:4096
    ds_read_b64_tr_b16 v[22:23], v2 offset:6144
    ds_read_b64_tr_b16 v[24:25], v2 offset:8192
    ds_read_b64_tr_b16 v[26:27], v2 offset:10240
    ds_read_b64_tr_b16 v[28:29], v2 offset:12288
    ds_read_b64_tr_b16 v[30:31], v2 offset:14336
    ds_read_b64_tr_b16 v[32:33], v2 offset:16384
    ds_read_b64_tr_b16 v[34:35], v2 offset:18432
    ds_read_b64_tr_b16 v[36:37], v2 offset:20480
    ds_read_b64_tr_b16 v[38:39], v2 offset:22528
    ds_read_b64_tr_b16 v[40:41], v2 offset:24576
    ds_read_b64_tr_b16 v[42:43], v2 offset:26624
    ds_read_b64_tr_b16 v[44:45], v2 offset:28672
    ds_read_b64_tr_b16 v[46:47], v2 offset:30720
    ds_read_b64_tr_b16 v[48:49], v2 offset:32768
    ds_read_b64_tr_b16 v[50:51], v2 offset:34816
    ds_read_b64_tr_b16 v[52:53], v2 offset:36864
    ds_read_b64_tr_b16 v[54:55], v2 offset:38912
    ds_read_b64_tr_b16 v[56:57], v4 offset:0
    ds_read_b64_tr_b16 v[58:59], v4 offset:2048
    ds_read_b64_tr_b16 v[60:61], v4 offset:4096
    ds_read_b64_tr_b16 v[62:63], v4 offset:6144
    ds_read_b64_tr_b16 v[64:65], v4 offset:8192
    ds_read_b64_tr_b16 v[66:67], v4 offset:10240
    ds_read_b64_tr_b16 v[68:69], v4 offset:12288
    ds_read_b64_tr_b16 v[70:71], v4 offset:14336
    ds_read_b64_tr_b16 v[72:73], v4 offset:16384
    ds_read_b64_tr_b16 v[74:75], v4 offset:18432
    ds_read_b64_tr_b16 v[76:77], v4 offset:20480
    ds_read_b64_tr_b16 v[78:79], v4 offset:22528
    ds_read_b64_tr_b16 v[80:81], v4 offset:24576
    ds_read_b64_tr_b16 v[82:83], v4 offset:26624
    ds_read_b64_tr_b16 v[84:85], v4 offset:28672
    ds_read_b64_tr_b16 v[86:87], v4 offset:30720
    ds_read_b64_tr_b16 v[88:89], v4 offset:32768
    ds_read_b64_tr_b16 v[90:91], v4 offset:34816
    ds_read_b64_tr_b16 v[92:93], v4 offset:36864
    ds_read_b64_tr_b16 v[94:95], v4 offset:38912
    v_mov_b32 v8, 0
    v_mov_b32 v9, 0
    v_mov_b32 v10, 0x3f803f80
    s_mov_b32 s47, 0xffff0000
    s_waitcnt lgkmcnt(0)
    v_dot2c_f32_bf16 v8, v10, v16
    v_dot2c_f32_bf16 v9, v10, v17
    v_dot2c_f32_bf16 v8, v10, v18
    v_dot2c_f32_bf16 v9, v10, v19
    v_dot2c_f32_bf16 v8, v10, v20
    v_dot2c_f32_bf16 v9, v10, v21
    v_dot2c_f32_bf16 v8, v10, v22
    v_dot2c_f32_bf16 v9, v10, v23
    v_dot2c_f32_bf16 v8, v10, v24
    v_dot2c_f32_bf16 v9, v10, v25
    v_dot2c_f32_bf16 v8, v10, v26
    v_dot2c_f32_bf16 v9, v10, v27
    v_dot2c_f32_bf16 v8, v10, v28
    v_dot2c_f32_bf16 v9, v10, v29
    v_dot2c_f32_bf16 v8, v10, v30
    v_dot2c_f32_bf16 v9, v10, v31
    v_dot2c_f32_bf16 v8, v10, v32
    v_dot2c_f32_bf16 v9, v10, v33
    v_dot2c_f32_bf16 v8, v10, v34
    v_dot2c_f32_bf16 v9, v10, v35
    v_dot2c_f32_bf16 v8, v10, v36
    v_dot2c_f32_bf16 v9, v10, v37
    v_dot2c_f32_bf16 v8, v10, v38
    v_dot2c_f32_bf16 v9, v10, v39
    v_dot2c_f32_bf16 v8, v10, v40
    v_dot2c_f32_bf16 v9, v10, v41
    v_dot2c_f32_bf16 v8, v10, v42
    v_dot2c_f32_bf16 v9, v10, v43
    v_dot2c_f32_bf16 v8, v10, v44
    v_dot2c_f32_bf16 v9, v10, v45
    v_dot2c_f32_bf16 v8, v10, v46
    v_dot2c_f32_bf16 v9, v10, v47
    v_dot2c_f32_bf16 v8, v10, v48
    v_dot2c_f32_bf16 v9, v10, v49
    v_dot2c_f32_bf16 v8, v10, v50
    v_dot2c_f32_bf16 v9, v10, v51
    v_dot2c_f32_bf16 v8, v10, v52
    v_dot2c_f32_bf16 v9, v10, v53
    v_dot2c_f32_bf16 v8, v10, v54
    v_dot2c_f32_bf16 v9, v10, v55
    v_dot2c_f32_bf16 v8, v10, v56
    v_dot2c_f32_bf16 v9, v10, v57
    v_dot2c_f32_bf16 v8, v10, v58
    v_dot2c_f32_bf16 v9, v10, v59
    v_dot2c_f32_bf16 v8, v10, v60
    v_dot2c_f32_bf16 v9, v10, v61
    v_dot2c_f32_bf16 v8, v10, v62
    v_dot2c_f32_bf16 v9, v10, v63
    v_dot2c_f32_bf16 v8, v10, v64
    v_dot2c_f32_bf16 v9, v10, v65
    v_dot2c_f32_bf16 v8, v10, v66
    v_dot2c_f32_bf16 v9, v10, v67
    v_dot2c_f32_bf16 v8, v10, v68
    v_dot2c_f32_bf16 v9, v10, v69
    v_dot2c_f32_bf16 v8, v10, v70
    v_dot2c_f32_bf16 v9, v10, v71
    v_dot2c_f32_bf16 v8, v10, v72
    v_dot2c_f32_bf16 v9, v10, v73
    v_dot2c_f32_bf16 v8, v10, v74
    v_dot2c_f32_bf16 v9, v10, v75
    v_dot2c_f32_bf16 v8, v10, v76
    v_dot2c_f32_bf16 v9, v10, v77
    v_dot2c_f32_bf16 v8, v10, v78
    v_dot2c_f32_bf16 v9, v10, v79
    v_dot2c_f32_bf16 v8, v10, v80
    v_dot2c_f32_bf16 v9, v10, v81
    v_dot2c_f32_bf16 v8, v10, v82
    v_dot2c_f32_bf16 v9, v10, v83
    v_dot2c_f32_bf16 v8, v10, v84
    v_dot2c_f32_bf16 v9, v10, v85
    v_dot2c_f32_bf16 v8, v10, v86
    v_dot2c_f32_bf16 v9, v10, v87
    v_dot2c_f32_bf16 v8, v10, v88
    v_dot2c_f32_bf16 v9, v10, v89
    v_dot2c_f32_bf16 v8, v10, v90
    v_dot2c_f32_bf16 v9, v10, v91
    v_dot2c_f32_bf16 v8, v10, v92
    v_dot2c_f32_bf16 v9, v10, v93
    v_dot2c_f32_bf16 v8, v10, v94
    v_dot2c_f32_bf16 v9, v10, v95
    s_nop 2
    v_add_f32 v8, v8, v9
    v_mov_b32 v9, v8
    s_nop 1
    v_permlane16_swap_b32 v8, v9
    s_nop 1
    v_add_f32 v8, v8, v9
    v_mov_b32 v9, v8
    s_nop 1
    v_permlane32_swap_b32 v8, v9
    s_nop 1
    v_add_f32 v8, v8, v9
    v_mul_f32 v8, 0xbacccccd, v8
    s_mov_b32 s47, 0x3f80
    s_mov_b32 s48, 0x3f800000
    .p2align 3
    v_dot2_f32_bf16 v100, v16, s47, v8
    v_dot2_f32_bf16 v101, v16, s48, v8
    v_dot2_f32_bf16 v102, v17, s47, v8
    v_dot2_f32_bf16 v103, v17, s48, v8
    v_dot2_f32_bf16 v104, v18, s47, v8
    v_dot2_f32_bf16 v105, v18, s48, v8
    v_dot2_f32_bf16 v106, v19, s47, v8
    v_dot2_f32_bf16 v107, v19, s48, v8
    v_cvt_pk_bf16_f32 v16, v100, v101
    v_cvt_pk_bf16_f32 v17, v102, v103
    v_cvt_pk_bf16_f32 v18, v104, v105
    v_cvt_pk_bf16_f32 v19, v106, v107
    buffer_store_dwordx4 v[16:19], v5, s[12:15], s46 offen sc1
    s_add_u32 s46, s46, 14336
    v_dot2_f32_bf16 v100, v20, s47, v8
    v_dot2_f32_bf16 v101, v20, s48, v8
    v_dot2_f32_bf16 v102, v21, s47, v8
    v_dot2_f32_bf16 v103, v21, s48, v8
    v_dot2_f32_bf16 v104, v22, s47, v8
    v_dot2_f32_bf16 v105, v22, s48, v8
    v_dot2_f32_bf16 v106, v23, s47, v8
    v_dot2_f32_bf16 v107, v23, s48, v8
    v_cvt_pk_bf16_f32 v20, v100, v101
    v_cvt_pk_bf16_f32 v21, v102, v103
    v_cvt_pk_bf16_f32 v22, v104, v105
    v_cvt_pk_bf16_f32 v23, v106, v107
    buffer_store_dwordx4 v[20:23], v5, s[12:15], s46 offen sc1
    s_add_u32 s46, s46, 14336
    v_dot2_f32_bf16 v100, v24, s47, v8
    v_dot2_f32_bf16 v101, v24, s48, v8
    v_dot2_f32_bf16 v102, v25, s47, v8
    v_dot2_f32_bf16 v103, v25, s48, v8
    v_dot2_f32_bf16 v104, v26, s47, v8
    v_dot2_f32_bf16 v105, v26, s48, v8
    v_dot2_f32_bf16 v106, v27, s47, v8
    v_dot2_f32_bf16 v107, v27, s48, v8
    v_cvt_pk_bf16_f32 v24, v100, v101
    v_cvt_pk_bf16_f32 v25, v102, v103
    v_cvt_pk_bf16_f32 v26, v104, v105
    v_cvt_pk_bf16_f32 v27, v106, v107
    buffer_store_dwordx4 v[24:27], v5, s[12:15], s46 offen sc1
    s_add_u32 s46, s46, 14336
    v_dot2_f32_bf16 v100, v28, s47, v8
    v_dot2_f32_bf16 v101, v28, s48, v8
    v_dot2_f32_bf16 v102, v29, s47, v8
    v_dot2_f32_bf16 v103, v29, s48, v8
    v_dot2_f32_bf16 v104, v30, s47, v8
    v_dot2_f32_bf16 v105, v30, s48, v8
    v_dot2_f32_bf16 v106, v31, s47, v8
    v_dot2_f32_bf16 v107, v31, s48, v8
    v_cvt_pk_bf16_f32 v28, v100, v101
    v_cvt_pk_bf16_f32 v29, v102, v103
    v_cvt_pk_bf16_f32 v30, v104, v105
    v_cvt_pk_bf16_f32 v31, v106, v107
    buffer_store_dwordx4 v[28:31], v5, s[12:15], s46 offen sc1
    s_add_u32 s46, s46, 14336
    v_dot2_f32_bf16 v100, v32, s47, v8
    v_dot2_f32_bf16 v101, v32, s48, v8
    v_dot2_f32_bf16 v102, v33, s47, v8
    v_dot2_f32_bf16 v103, v33, s48, v8
    v_dot2_f32_bf16 v104, v34, s47, v8
    v_dot2_f32_bf16 v105, v34, s48, v8
    v_dot2_f32_bf16 v106, v35, s47, v8
    v_dot2_f32_bf16 v107, v35, s48, v8
    v_cvt_pk_bf16_f32 v32, v100, v101
    v_cvt_pk_bf16_f32 v33, v102, v103
    v_cvt_pk_bf16_f32 v34, v104, v105
    v_cvt_pk_bf16_f32 v35, v106, v107
    buffer_store_dwordx4 v[32:35], v5, s[12:15], s46 offen sc1
    s_add_u32 s46, s46, 14336
    v_dot2_f32_bf16 v100, v36, s47, v8
    v_dot2_f32_bf16 v101, v36, s48, v8
    v_dot2_f32_bf16 v102, v37, s47, v8
    v_dot2_f32_bf16 v103, v37, s48, v8
    v_dot2_f32_bf16 v104, v38, s47, v8
    v_dot2_f32_bf16 v105, v38, s48, v8
    v_dot2_f32_bf16 v106, v39, s47, v8
    v_dot2_f32_bf16 v107, v39, s48, v8
    v_cvt_pk_bf16_f32 v36, v100, v101
    v_cvt_pk_bf16_f32 v37, v102, v103
    v_cvt_pk_bf16_f32 v38, v104, v105
    v_cvt_pk_bf16_f32 v39, v106, v107
    buffer_store_dwordx4 v[36:39], v5, s[12:15], s46 offen sc1
    s_add_u32 s46, s46, 14336
    v_dot2_f32_bf16 v100, v40, s47, v8
    v_dot2_f32_bf16 v101, v40, s48, v8
    v_dot2_f32_bf16 v102, v41, s47, v8
    v_dot2_f32_bf16 v103, v41, s48, v8
    v_dot2_f32_bf16 v104, v42, s47, v8
    v_dot2_f32_bf16 v105, v42, s48, v8
    v_dot2_f32_bf16 v106, v43, s47, v8
    v_dot2_f32_bf16 v107, v43, s48, v8
    v_cvt_pk_bf16_f32 v40, v100, v101
    v_cvt_pk_bf16_f32 v41, v102, v103
    v_cvt_pk_bf16_f32 v42, v104, v105
    v_cvt_pk_bf16_f32 v43, v106, v107
    buffer_store_dwordx4 v[40:43], v5, s[12:15], s46 offen sc1
    s_add_u32 s46, s46, 14336
    v_dot2_f32_bf16 v100, v44, s47, v8
    v_dot2_f32_bf16 v101, v44, s48, v8
    v_dot2_f32_bf16 v102, v45, s47, v8
    v_dot2_f32_bf16 v103, v45, s48, v8
    v_dot2_f32_bf16 v104, v46, s47, v8
    v_dot2_f32_bf16 v105, v46, s48, v8
    v_dot2_f32_bf16 v106, v47, s47, v8
    v_dot2_f32_bf16 v107, v47, s48, v8
    v_cvt_pk_bf16_f32 v44, v100, v101
    v_cvt_pk_bf16_f32 v45, v102, v103
    v_cvt_pk_bf16_f32 v46, v104, v105
    v_cvt_pk_bf16_f32 v47, v106, v107
    buffer_store_dwordx4 v[44:47], v5, s[12:15], s46 offen sc1
    s_add_u32 s46, s46, 14336
    v_dot2_f32_bf16 v100, v48, s47, v8
    v_dot2_f32_bf16 v101, v48, s48, v8
    v_dot2_f32_bf16 v102, v49, s47, v8
    v_dot2_f32_bf16 v103, v49, s48, v8
    v_dot2_f32_bf16 v104, v50, s47, v8
    v_dot2_f32_bf16 v105, v50, s48, v8
    v_dot2_f32_bf16 v106, v51, s47, v8
    v_dot2_f32_bf16 v107, v51, s48, v8
    v_cvt_pk_bf16_f32 v48, v100, v101
    v_cvt_pk_bf16_f32 v49, v102, v103
    v_cvt_pk_bf16_f32 v50, v104, v105
    v_cvt_pk_bf16_f32 v51, v106, v107
    buffer_store_dwordx4 v[48:51], v5, s[12:15], s46 offen sc1
    s_add_u32 s46, s46, 14336
    v_dot2_f32_bf16 v100, v52, s47, v8
    v_dot2_f32_bf16 v101, v52, s48, v8
    v_dot2_f32_bf16 v102, v53, s47, v8
    v_dot2_f32_bf16 v103, v53, s48, v8
    v_dot2_f32_bf16 v104, v54, s47, v8
    v_dot2_f32_bf16 v105, v54, s48, v8
    v_dot2_f32_bf16 v106, v55, s47, v8
    v_dot2_f32_bf16 v107, v55, s48, v8
    v_cvt_pk_bf16_f32 v52, v100, v101
    v_cvt_pk_bf16_f32 v53, v102, v103
    v_cvt_pk_bf16_f32 v54, v104, v105
    v_cvt_pk_bf16_f32 v55, v106, v107
    buffer_store_dwordx4 v[52:55], v5, s[12:15], s46 offen sc1
    s_add_u32 s46, s46, 14336
    v_dot2_f32_bf16 v100, v56, s47, v8
    v_dot2_f32_bf16 v101, v56, s48, v8
    v_dot2_f32_bf16 v102, v57, s47, v8
    v_dot2_f32_bf16 v103, v57, s48, v8
    v_dot2_f32_bf16 v104, v58, s47, v8
    v_dot2_f32_bf16 v105, v58, s48, v8
    v_dot2_f32_bf16 v106, v59, s47, v8
    v_dot2_f32_bf16 v107, v59, s48, v8
    v_cvt_pk_bf16_f32 v56, v100, v101
    v_cvt_pk_bf16_f32 v57, v102, v103
    v_cvt_pk_bf16_f32 v58, v104, v105
    v_cvt_pk_bf16_f32 v59, v106, v107
    buffer_store_dwordx4 v[56:59], v5, s[12:15], s46 offen sc1
    s_add_u32 s46, s46, 14336
    v_mov_b32 v11, 163328
    v_mov_b32 v12, 1
    s_waitcnt vmcnt(5)
    s_mov_b64 exec, 1
    ds_add_rtn_u32 v13, v11, v12 offset:8
    s_mov_b64 exec, -1
    s_add_u32 s44, s54, 0x9e3779b9
    v_and_b32 v14, 31, v1
    v_lshlrev_b32 v14, 2, v14
    v_mov_b32 v15, s44
    s_lshl_b32 s45, s2, 7
    s_add_u32 s45, s45, 0x1880000
    s_waitcnt lgkmcnt(0)
    v_readfirstlane_b32 s44, v13
    s_cmp_lg_u32 s44, 3
    s_cbranch_scc1 K1_NOFE
    s_mov_b32 exec_hi, 0
    buffer_store_dword v15, v14, s[12:15], s45 offen sc1
    s_mov_b32 exec_hi, -1
K1_NOFE:
    v_dot2_f32_bf16 v100, v60, s47, v8
    v_dot2_f32_bf16 v101, v60, s48, v8
    v_dot2_f32_bf16 v102, v61, s47, v8
    v_dot2_f32_bf16 v103, v61, s48, v8
    v_dot2_f32_bf16 v104, v62, s47, v8
    v_dot2_f32_bf16 v105, v62, s48, v8
    v_dot2_f32_bf16 v106, v63, s47, v8
    v_dot2_f32_bf16 v107, v63, s48, v8
    v_cvt_pk_bf16_f32 v60, v100, v101
    v_cvt_pk_bf16_f32 v61, v102, v103
    v_cvt_pk_bf16_f32 v62, v104, v105
    v_cvt_pk_bf16_f32 v63, v106, v107
    buffer_store_dwordx4 v[60:63], v5, s[12:15], s46 offen sc1
    s_add_u32 s46, s46, 14336
    v_dot2_f32_bf16 v100, v64, s47, v8
    v_dot2_f32_bf16 v101, v64, s48, v8
    v_dot2_f32_bf16 v102, v65, s47, v8
    v_dot2_f32_bf16 v103, v65, s48, v8
    v_dot2_f32_bf16 v104, v66, s47, v8
    v_dot2_f32_bf16 v105, v66, s48, v8
    v_dot2_f32_bf16 v106, v67, s47, v8
    v_dot2_f32_bf16 v107, v67, s48, v8
    v_cvt_pk_bf16_f32 v64, v100, v101
    v_cvt_pk_bf16_f32 v65, v102, v103
    v_cvt_pk_bf16_f32 v66, v104, v105
    v_cvt_pk_bf16_f32 v67, v106, v107
    buffer_store_dwordx4 v[64:67], v5, s[12:15], s46 offen sc1
    s_add_u32 s46, s46, 14336
    v_dot2_f32_bf16 v100, v68, s47, v8
    v_dot2_f32_bf16 v101, v68, s48, v8
    v_dot2_f32_bf16 v102, v69, s47, v8
    v_dot2_f32_bf16 v103, v69, s48, v8
    v_dot2_f32_bf16 v104, v70, s47, v8
    v_dot2_f32_bf16 v105, v70, s48, v8
    v_dot2_f32_bf16 v106, v71, s47, v8
    v_dot2_f32_bf16 v107, v71, s48, v8
    v_cvt_pk_bf16_f32 v68, v100, v101
    v_cvt_pk_bf16_f32 v69, v102, v103
    v_cvt_pk_bf16_f32 v70, v104, v105
    v_cvt_pk_bf16_f32 v71, v106, v107
    buffer_store_dwordx4 v[68:71], v5, s[12:15], s46 offen sc1
    s_add_u32 s46, s46, 14336
    v_dot2_f32_bf16 v100, v72, s47, v8
    v_dot2_f32_bf16 v101, v72, s48, v8
    v_dot2_f32_bf16 v102, v73, s47, v8
    v_dot2_f32_bf16 v103, v73, s48, v8
    v_dot2_f32_bf16 v104, v74, s47, v8
    v_dot2_f32_bf16 v105, v74, s48, v8
    v_dot2_f32_bf16 v106, v75, s47, v8
    v_dot2_f32_bf16 v107, v75, s48, v8
    v_cvt_pk_bf16_f32 v72, v100, v101
    v_cvt_pk_bf16_f32 v73, v102, v103
    v_cvt_pk_bf16_f32 v74, v104, v105
    v_cvt_pk_bf16_f32 v75, v106, v107
    buffer_store_dwordx4 v[72:75], v5, s[12:15], s46 offen sc1
    s_add_u32 s46, s46, 14336
    v_dot2_f32_bf16 v100, v76, s47, v8
    v_dot2_f32_bf16 v101, v76, s48, v8
    v_dot2_f32_bf16 v102, v77, s47, v8
    v_dot2_f32_bf16 v103, v77, s48, v8
    v_dot2_f32_bf16 v104, v78, s47, v8
    v_dot2_f32_bf16 v105, v78, s48, v8
    v_dot2_f32_bf16 v106, v79, s47, v8
    v_dot2_f32_bf16 v107, v79, s48, v8
    v_cvt_pk_bf16_f32 v76, v100, v101
    v_cvt_pk_bf16_f32 v77, v102, v103
    v_cvt_pk_bf16_f32 v78, v104, v105
    v_cvt_pk_bf16_f32 v79, v106, v107
    buffer_store_dwordx4 v[76:79], v5, s[12:15], s46 offen sc1
    s_add_u32 s46, s46, 14336
    v_dot2_f32_bf16 v100, v80, s47, v8
    v_dot2_f32_bf16 v101, v80, s48, v8
    v_dot2_f32_bf16 v102, v81, s47, v8
    v_dot2_f32_bf16 v103, v81, s48, v8
    v_dot2_f32_bf16 v104, v82, s47, v8
    v_dot2_f32_bf16 v105, v82, s48, v8
    v_dot2_f32_bf16 v106, v83, s47, v8
    v_dot2_f32_bf16 v107, v83, s48, v8
    v_cvt_pk_bf16_f32 v80, v100, v101
    v_cvt_pk_bf16_f32 v81, v102, v103
    v_cvt_pk_bf16_f32 v82, v104, v105
    v_cvt_pk_bf16_f32 v83, v106, v107
    buffer_store_dwordx4 v[80:83], v5, s[12:15], s46 offen sc1
    s_add_u32 s46, s46, 14336
    v_dot2_f32_bf16 v100, v84, s47, v8
    v_dot2_f32_bf16 v101, v84, s48, v8
    v_dot2_f32_bf16 v102, v85, s47, v8
    v_dot2_f32_bf16 v103, v85, s48, v8
    v_dot2_f32_bf16 v104, v86, s47, v8
    v_dot2_f32_bf16 v105, v86, s48, v8
    v_dot2_f32_bf16 v106, v87, s47, v8
    v_dot2_f32_bf16 v107, v87, s48, v8
    v_cvt_pk_bf16_f32 v84, v100, v101
    v_cvt_pk_bf16_f32 v85, v102, v103
    v_cvt_pk_bf16_f32 v86, v104, v105
    v_cvt_pk_bf16_f32 v87, v106, v107
    buffer_store_dwordx4 v[84:87], v5, s[12:15], s46 offen sc1
    s_add_u32 s46, s46, 14336
    v_dot2_f32_bf16 v100, v88, s47, v8
    v_dot2_f32_bf16 v101, v88, s48, v8
    v_dot2_f32_bf16 v102, v89, s47, v8
    v_dot2_f32_bf16 v103, v89, s48, v8
    v_dot2_f32_bf16 v104, v90, s47, v8
    v_dot2_f32_bf16 v105, v90, s48, v8
    v_dot2_f32_bf16 v106, v91, s47, v8
    v_dot2_f32_bf16 v107, v91, s48, v8
    v_cvt_pk_bf16_f32 v88, v100, v101
    v_cvt_pk_bf16_f32 v89, v102, v103
    v_cvt_pk_bf16_f32 v90, v104, v105
    v_cvt_pk_bf16_f32 v91, v106, v107
    buffer_store_dwordx4 v[88:91], v5, s[12:15], s46 offen sc1
    s_add_u32 s46, s46, 14336
    v_dot2_f32_bf16 v100, v92, s47, v8
    v_dot2_f32_bf16 v101, v92, s48, v8
    v_dot2_f32_bf16 v102, v93, s47, v8
    v_dot2_f32_bf16 v103, v93, s48, v8
    v_dot2_f32_bf16 v104, v94, s47, v8
    v_dot2_f32_bf16 v105, v94, s48, v8
    v_dot2_f32_bf16 v106, v95, s47, v8
    v_dot2_f32_bf16 v107, v95, s48, v8
    v_cvt_pk_bf16_f32 v92, v100, v101
    v_cvt_pk_bf16_f32 v93, v102, v103
    v_cvt_pk_bf16_f32 v94, v104, v105
    v_cvt_pk_bf16_f32 v95, v106, v107
    buffer_store_dwordx4 v[92:95], v5, s[12:15], s46 offen sc1
    s_add_u32 s46, s46, 14336
    s_branch K2_COMPP
K1_PREPD:
    s_sub_u32 s3, s3, 54
    s_mov_b32 s8, s92
    s_mov_b32 s9, s93
    s_mov_b32 s10, 0x21c000
    s_mov_b32 s11, 0x00020000
    v_add_u32 v2, 0, v1
    v_mul_u32_u24 v3, 6554, v2
    v_lshrrev_b32 v3, 16, v3
    v_mul_u32_u24 v4, 1120, v3
    v_lshl_add_u32 v40, v2, 4, v4
    v_lshrrev_b32 v45, 4, v3
    v_add_u32 v2, 64, v1
    v_mul_u32_u24 v3, 6554, v2
    v_lshrrev_b32 v3, 16, v3
    v_mul_u32_u24 v4, 1120, v3
    v_lshl_add_u32 v41, v2, 4, v4
    v_lshrrev_b32 v46, 4, v3
    v_add_u32 v2, 128, v1
    v_mul_u32_u24 v3, 6554, v2
    v_lshrrev_b32 v3, 16, v3
    v_mul_u32_u24 v4, 1120, v3
    v_lshl_add_u32 v42, v2, 4, v4
    v_lshrrev_b32 v47, 4, v3
    v_add_u32 v2, 192, v1
    v_mul_u32_u24 v3, 6554, v2
    v_lshrrev_b32 v3, 16, v3
    v_mul_u32_u24 v4, 1120, v3
    v_lshl_add_u32 v43, v2, 4, v4
    v_lshrrev_b32 v48, 4, v3
    v_add_u32 v2, 256, v1
    v_mul_u32_u24 v3, 6554, v2
    v_lshrrev_b32 v3, 16, v3
    v_mul_u32_u24 v4, 1120, v3
    v_lshl_add_u32 v44, v2, 4, v4
    v_lshrrev_b32 v49, 4, v3
    s_mul_i32 s40, s3, 12
    s_add_u32 s40, s40, s4
    s_mul_i32 s49, s4, 15360
    s_mov_b32 s45, 0
K1_PD1:
    s_lshr_b32 s36, s40, 3
    s_mul_i32 s37, s36, 9363
    s_lshr_b32 s37, s37, 16
    s_mul_i32 s38, s37, 7
    s_sub_u32 s38, s36, s38
    s_lshl_b32 s39, s38, 3
    s_mov_b32 s50, 0xa3546210
    s_mov_b32 s51, 0xcbd987
    s_lshr_b64 s[50:51], s[50:51], s39
    s_mul_i32 s37, s37, 14
    s_and_b32 s48, s50, 15
    s_add_u32 s48, s48, s37
    s_lshr_b32 s50, s50, 4
    s_and_b32 s50, s50, 15
    s_add_u32 s50, s50, s37
    s_min_u32 s50, s50, 107
    s_sub_u32 s50, s50, s48
    s_sub_u32 s50, s50, 1
    s_mul_i32 s39, s50, 20480
    s_mul_i32 s48, s48, 20480
    s_and_b32 s37, s40, 7
    s_mul_i32 s37, s37, 160
    s_add_u32 s48, s48, s37
    s_add_u32 m0, s49, 0
    v_mad_u32_u24 v2, v45, s39, v40
    buffer_load_dwordx4 v2, s[8:11], s48 offen nt lds
    s_add_u32 m0, s49, 1024
    v_mad_u32_u24 v2, v46, s39, v41
    buffer_load_dwordx4 v2, s[8:11], s48 offen nt lds
    s_add_u32 m0, s49, 2048
    v_mad_u32_u24 v2, v47, s39, v42
    buffer_load_dwordx4 v2, s[8:11], s48 offen nt lds
    s_add_u32 m0, s49, 3072
    v_mad_u32_u24 v2, v48, s39, v43
    buffer_load_dwordx4 v2, s[8:11], s48 offen nt lds
    s_add_u32 m0, s49, 4096
    v_mad_u32_u24 v2, v49, s39, v44
    buffer_load_dwordx4 v2, s[8:11], s48 offen nt lds
    s_add_u32 s40, s40, 4
    s_add_u32 s49, s49, 5120
    s_add_u32 s45, s45, 1
    s_cmp_lg_u32 s45, 1
    s_cbranch_scc1 K1_PD2
K1_PD2:
    s_cmp_lt_u32 s45, 3
    s_cbranch_scc1 K1_PD1
    s_sub_u32 s40, s40, 12
    s_sub_u32 s49, s49, 15360
    v_lshrrev_b32 v6, 4, v1
    v_bfe_u32 v7, v1, 2, 2
    v_and_b32 v8, 3, v1
    v_lshlrev_b32 v5, 4, v1
    s_waitcnt vmcnt(0)
    s_barrier
K1_PD3:
    s_lshr_b32 s36, s40, 3
    s_mul_i32 s37, s36, 9363
    s_lshr_b32 s37, s37, 16
    s_mul_i32 s38, s37, 7
    s_sub_u32 s38, s36, s38
    s_lshr_b32 s39, s38, 1
    s_mul_i32 s36, s37, 3
    s_lshl_b32 s37, s37, 2
    s_add_u32 s37, s37, 23
    s_and_b32 s38, s38, 1
    s_cselect_b32 s36, s36, s37
    s_add_u32 s36, s36, s39
    v_lshlrev_b32 v2, s38, v6
    v_lshl_add_u32 v2, v2, 2, v7
    v_mul_u32_u24 v2, 160, v2
    v_lshl_add_u32 v2, v8, 3, v2
    v_add_u32 v2, s49, v2
    s_cmp_eq_u32 s38, 1
    s_movk_i32 s38, 2560
    s_cselect_b32 s38, 640, s38
    v_add_u32 v3, s38, v2
    s_and_b32 s37, s40, 7
    s_mul_i32 s37, s37, 276480
    s_mul_i32 s36, s36, 5120
    s_add_u32 s50, s37, s36
    s_add_u32 s50, s50, 0x6f0000
    s_add_u32 s51, s50, 4096
    ds_read_b64_tr_b16 v[16:17], v2 offset:0
    ds_read_b64_tr_b16 v[18:19], v3 offset:0
    ds_read_b64_tr_b16 v[20:21], v2 offset:32
    ds_read_b64_tr_b16 v[22:23], v3 offset:32
    ds_read_b64_tr_b16 v[24:25], v2 offset:64
    ds_read_b64_tr_b16 v[26:27], v3 offset:64
    ds_read_b64_tr_b16 v[28:29], v2 offset:96
    ds_read_b64_tr_b16 v[30:31], v3 offset:96
    ds_read_b64_tr_b16 v[32:33], v2 offset:128
    ds_read_b64_tr_b16 v[34:35], v3 offset:128
    s_waitcnt lgkmcnt(0)
    buffer_store_dwordx4 v[16:19], v5, s[12:15], s50 offen offset:0 sc1
    buffer_store_dwordx4 v[20:23], v5, s[12:15], s50 offen offset:1024 sc1
    buffer_store_dwordx4 v[24:27], v5, s[12:15], s50 offen offset:2048 sc1
    buffer_store_dwordx4 v[28:31], v5, s[12:15], s50 offen offset:3072 sc1
    buffer_store_dwordx4 v[32:35], v5, s[12:15], s51 offen offset:0 sc1
    s_add_u32 s40, s40, 4
    s_add_u32 s49, s49, 5120
    s_sub_u32 s45, s45, 1
    s_cmp_lg_u32 s45, 0
    s_cbranch_scc1 K1_PD3
    s_branch K2_COMPP
K2_LSETUP:
    s_and_b32 s3, s2, 7
    s_lshr_b32 s5, s2, 3
    s_cmp_lt_u32 s5, 20
    s_cselect_b32 s16, 0, 20
    s_cselect_b32 s17, 5, 3
    s_cselect_b32 s18, 52, 86
    s_cselect_b32 s19, 0, 10
    s_sub_u32 s5, s5, s16
    s_mul_i32 s18, s5, s18
    s_lshr_b32 s18, s18, 8
    s_mul_i32 s36, s18, s17
    s_sub_u32 s5, s5, s36
    s_lshr_b32 s38, s3, 1
    s_and_b32 s3, s3, 1
    s_mul_i32 s36, s38, s17
    s_add_u32 s36, s36, s5
    s_add_u32 s36, s36, s16
    s_lshl_b32 s37, s3, 2
    s_add_u32 s37, s37, s18
    s_mul_i32 s16, s3, s17
    s_add_u32 s16, s16, s5
    s_add_u32 s16, s16, s19
    s_lshl_b32 s17, s38, 2
    s_add_u32 s17, s17, s18
    s_lshr_b32 s18, s4, 1
    s_and_b32 s19, s4, 1
    v_lshlrev_b32 v4, 4, v1
    s_mul_i32 s35, s37, 276480
    s_add_u32 s35, s35, 0x6f0000
    s_mul_i32 s26, s4, 15360
    s_add_u32 s29, s35, s26
    s_add_u32 s29, s29, 153600
    v_min_u32 v13, 35, v1
    v_lshlrev_b32 v13, 7, v13
    v_add_u32 v13, 0x1866b00, v13
    s_mul_i32 s20, s17, 7
    s_lshr_b32 s20, s20, 2
    v_and_b32 v7, 3, v1
    v_min_u32 v7, 2, v7
    v_add_u32 v7, s20, v7
    v_min_u32 v7, 26, v7
    v_bfe_u32 v6, v1, 2, 1
    v_mad_u32_u24 v7, v6, 27, v7
    v_add_u32 v12, 160, v7
    v_lshlrev_b32 v7, 7, v7
    v_add_u32 v10, 0x1885000, v7
    v_lshrrev_b32 v8, 4, v1
    v_and_b32 v6, 15, v1
    v_lshlrev_b32 v7, 1, v8
    v_xor_b32 v2, v6, v7
    v_xor_b32 v3, 8, v2
    v_lshlrev_b32 v7, 12, v8
    v_lshl_add_u32 v2, v2, 4, v7
    v_lshl_add_u32 v3, v3, 4, v7
    s_lshl_b32 s20, s4, 16
    s_lshl_b32 s21, s16, 8
    s_add_u32 s20, s20, s21
    s_add_u32 s20, s20, 0x10000
    s_mul_i32 s21, s17, 286720
    s_mul_i32 s22, s4, 7168
    s_add_u32 s21, s21, s22
    s_add_u32 s21, s21, 0x290000
    s_cmp_eq_u32 s17, 15
    s_cselect_b32 s25, 0x40000000, 0
    v_add_u32 v246, s25, v4
    s_mul_i32 s25, s25, s19
    s_add_u32 s21, s21, s25
    s_lshl_b32 s23, s4, 12
    s_add_u32 s23, s23, 16384
    s_add_u32 s24, s22, 77824
    s_mov_b32 s33, 16384
    s_mov_b32 s34, 28672
    v_min_u32 v7, 39, v1
    v_lshrrev_b32 v8, 2, v7
    v_and_b32 v7, 3, v7
    v_lshl_add_u32 v7, v8, 4, v7
    s_lshl_b32 s22, s4, 2
    v_add_u32 v7, s22, v7
    v_cmp_gt_u32 vcc, 56, v1
    s_nop 1
    v_cndmask_b32 v7, v12, v7, vcc
    v_lshlrev_b32 v7, 7, v7
    v_add_u32 v7, 0x1860000, v7
    s_cmp_lt_u32 s2, 160
    s_cselect_b32 s22, 0x28000, 0
    v_mov_b32 v8, s22
    v_cndmask_b32 v8, 0, v8, vcc
    v_add_u32 v7, v7, v8
    v_mov_b32 v8, 163328
    s_lshl_b32 s31, s4, 10
    s_add_u32 s30, s35, s31
    v_lshrrev_b32 v240, 3, v1
    v_and_b32 v241, 7, v1
    v_lshlrev_b32 v240, 12, v240
    v_lshl_add_u32 v242, v241, 4, v240
    s_mul_i32 s40, s37, 327680
    s_lshl_b32 s41, s36, 7
    s_add_u32 s40, s40, s41
    s_add_u32 s40, s40, 0x10000
    s_lshl_b32 s41, s4, 15
    s_add_u32 s40, s40, s41
    s_add_u32 s42, s31, 135168
    s_add_u32 s41, s31, 153600
    v_add_u32 v240, s26, v4
    v_add_u32 v243, 61440, v240
    v_add_u32 v244, s31, v4
    v_add_u32 v245, 0x10000, v244
    v_lshl_add_u32 v241, s4, 3, v241
    v_lshlrev_b32 v241, 6, v241
    s_lshl_b32 s38, s36, 11
    s_add_u32 s39, s38, 0x1850000
    s_add_u32 s38, s38, 0x1840000
    s_cmp_lt_u32 s2, 160
    s_cbranch_scc1 K1_BACK
    s_mov_b32 s52, 0
K2_P1Q:
    buffer_load_dword v6, v10, s[12:15], 0 offen sc1
    s_add_u32 s52, s52, 1
    s_waitcnt vmcnt(0)
    v_cmp_ne_u32 vcc, s54, v6
    s_cmp_lt_u32 s52, 0x40000
    s_cbranch_vccz K2_P1Q_D
    s_mov_b64 exec, vcc
    s_sleep 8
    s_cbranch_scc1 K2_P1Q
K2_P1Q_D:
    s_mov_b64 exec, -1
    s_mov_b32 m0, s24
    s_add_u32 s25, s21, 4096
    buffer_load_dwordx4 v4, s[12:15], s21 offen offset:0 sc1 lds
    buffer_load_dwordx4 v4, s[12:15], s21 offen offset:1024 sc1 lds
    buffer_load_dwordx4 v4, s[12:15], s21 offen offset:2048 sc1 lds
    buffer_load_dwordx4 v4, s[12:15], s21 offen offset:3072 sc1 lds
    s_add_u32 m0, s24, 4096
    s_add_u32 s21, s21, 28672
    buffer_load_dwordx4 v4, s[12:15], s25 offen offset:0 sc1 lds
    buffer_load_dwordx4 v4, s[12:15], s25 offen offset:1024 sc1 lds
    buffer_load_dwordx4 v246, s[12:15], s25 offen offset:2048 sc1 lds
    s_add_u32 s24, s24, 28672
    s_mov_b32 m0, s24
    s_add_u32 s25, s21, 4096
    buffer_load_dwordx4 v4, s[12:15], s21 offen offset:0 sc1 lds
    buffer_load_dwordx4 v4, s[12:15], s21 offen offset:1024 sc1 lds
    buffer_load_dwordx4 v4, s[12:15], s21 offen offset:2048 sc1 lds
    buffer_load_dwordx4 v4, s[12:15], s21 offen offset:3072 sc1 lds
    s_add_u32 m0, s24, 4096
    s_add_u32 s21, s21, 28672
    buffer_load_dwordx4 v4, s[12:15], s25 offen offset:0 sc1 lds
    buffer_load_dwordx4 v4, s[12:15], s25 offen offset:1024 sc1 lds
    buffer_load_dwordx4 v246, s[12:15], s25 offen offset:2048 sc1 lds
    s_sub_u32 s24, s24, 57344
    s_mov_b32 m0, s24
    s_add_u32 s25, s21, 4096
    buffer_load_dwordx4 v4, s[12:15], s21 offen offset:0 sc1 lds
    buffer_load_dwordx4 v4, s[12:15], s21 offen offset:1024 sc1 lds
    buffer_load_dwordx4 v4, s[12:15], s21 offen offset:2048 sc1 lds
    buffer_load_dwordx4 v4, s[12:15], s21 offen offset:3072 sc1 lds
    s_add_u32 m0, s24, 4096
    s_add_u32 s21, s21, 28672
    buffer_load_dwordx4 v4, s[12:15], s25 offen offset:0 sc1 lds
    buffer_load_dwordx4 v4, s[12:15], s25 offen offset:1024 sc1 lds
    buffer_load_dwordx4 v246, s[12:15], s25 offen offset:2048 sc1 lds
    s_add_u32 s24, s24, 28672
    s_lshl_b32 s3, s2, 7
    s_add_u32 s43, s3, 0x188b000
    v_writelane_b32 v13, s43, 63
    s_add_u32 s3, s3, 0x1873000
    v_mov_b32 v11, s3
    s_mov_b32 s52, 0
    s_mov_b32 s53, 0
K2_QW:
    buffer_load_dword v6, v13, s[12:15], 0 offen sc1
    s_add_u32 s52, s52, 1
    s_waitcnt vmcnt(0)
    v_cmp_ne_u32 s[44:45], s54, v6
    s_lshl_b64 s[46:47], s[44:45], 1
    s_cbranch_scc0 K2_QOK
    s_cmp_ge_i32 s45, 0
    s_cbranch_scc1 K2_QLATE
    s_mov_b64 exec, s[44:45]
    s_sleep 8
    s_cmp_lt_u32 s52, 0x40000
    s_cbranch_scc1 K2_QW
    s_branch K2_QLATE
K2_QOK:
    s_mov_b64 exec, -1
    s_mov_b32 s53, 1
    buffer_load_dwordx4 v[16:19], v4, s[12:15], s30 offen sc1
    s_add_u32 s30, s30, 4096
    buffer_load_dwordx4 v[20:23], v4, s[12:15], s30 offen sc1
    s_add_u32 s30, s30, 4096
    buffer_load_dwordx4 v[24:27], v4, s[12:15], s30 offen sc1
    s_add_u32 s30, s30, 4096
    buffer_load_dwordx4 v[28:31], v4, s[12:15], s30 offen sc1
    s_add_u32 s30, s30, 4096
    buffer_load_dwordx4 v[32:35], v4, s[12:15], s30 offen sc1
    s_add_u32 s30, s30, 4096
    buffer_load_dwordx4 v[36:39], v4, s[12:15], s30 offen sc1
    s_add_u32 s30, s30, 4096
    buffer_load_dwordx4 v[40:43], v4, s[12:15], s30 offen sc1
    s_add_u32 s30, s30, 4096
    buffer_load_dwordx4 v[44:47], v4, s[12:15], s30 offen sc1
    s_add_u32 s30, s30, 4096
    buffer_load_dwordx4 v[48:51], v4, s[12:15], s30 offen sc1
    s_add_u32 s30, s30, 4096
    buffer_load_dwordx4 v[52:55], v4, s[12:15], s30 offen sc1
    s_add_u32 s30, s30, 4096
    buffer_load_dwordx4 v[56:59], v4, s[12:15], s30 offen sc1
    s_add_u32 s30, s30, 4096
    buffer_load_dwordx4 v[60:63], v4, s[12:15], s30 offen sc1
    s_add_u32 s30, s30, 4096
    buffer_load_dwordx4 v[64:67], v4, s[12:15], s30 offen sc1
    s_add_u32 s30, s30, 4096
    buffer_load_dwordx4 v[68:71], v4, s[12:15], s30 offen sc1
    s_add_u32 s30, s30, 4096
    buffer_load_dwordx4 v[72:75], v4, s[12:15], s30 offen sc1
    s_add_u32 s30, s30, 4096
    buffer_load_dwordx4 v[76:79], v4, s[12:15], s30 offen sc1
    s_add_u32 s30, s30, 4096
    buffer_load_dwordx4 v[80:83], v4, s[12:15], s30 offen sc1
    s_add_u32 s30, s30, 4096
    buffer_load_dwordx4 v[84:87], v4, s[12:15], s30 offen sc1
    s_add_u32 s30, s30, 4096
    buffer_load_dwordx4 v[88:91], v4, s[12:15], s30 offen sc1
    s_add_u32 s30, s30, 4096
    buffer_load_dwordx4 v[92:95], v4, s[12:15], s30 offen sc1
    s_add_u32 s30, s30, 4096
    buffer_load_dwordx4 v[96:99], v4, s[12:15], s30 offen sc1
    s_add_u32 s30, s30, 4096
    buffer_load_dwordx4 v[100:103], v4, s[12:15], s30 offen sc1
    s_add_u32 s30, s30, 4096
    buffer_load_dwordx4 v[104:107], v4, s[12:15], s30 offen sc1
    s_add_u32 s30, s30, 4096
    buffer_load_dwordx4 v[108:111], v4, s[12:15], s30 offen sc1
    s_add_u32 s30, s30, 4096
    buffer_load_dwordx4 v[112:115], v4, s[12:15], s30 offen sc1
    s_add_u32 s30, s30, 4096
    buffer_load_dwordx4 v[116:119], v4, s[12:15], s30 offen sc1
    s_add_u32 s30, s30, 4096
    buffer_load_dwordx4 v[120:123], v4, s[12:15], s29 offen offset:0 sc1
    buffer_load_dwordx4 v[124:127], v4, s[12:15], s29 offen offset:1024 sc1
    buffer_load_dwordx4 v[128:131], v4, s[12:15], s29 offen offset:2048 sc1
    buffer_load_dwordx4 v[132:135], v4, s[12:15], s29 offen offset:3072 sc1
    s_add_u32 s29, s29, 4096
K2_QLATE:
    s_mov_b64 exec, -1
    s_mov_b32 s52, 0
K2_PH2:
    buffer_load_dword v6, v11, s[12:15], 0 offen sc1
    s_add_u32 s52, s52, 1
    s_waitcnt vmcnt(0)
    v_cmp_ne_u32 vcc, s54, v6
    s_cmp_lt_u32 s52, 0x40000
    s_cbranch_vccz K2_PH2_D
    s_mov_b64 exec, vcc
    s_sleep 8
    s_cbranch_scc1 K2_PH2
K2_PH2_D:
    s_mov_b64 exec, -1
    s_mov_b32 s52, 0
K2_PCQ:
    buffer_load_dword v6, v7, s[12:15], 0 offen sc1
    s_add_u32 s52, s52, 1
    s_waitcnt vmcnt(0)
    v_cmp_ne_u32 vcc, s54, v6
    s_cmp_lt_u32 s52, 0x40000
    s_cbranch_vccz K2_PCQ_D
    s_mov_b64 exec, vcc
    s_sleep 4
    s_cbranch_scc1 K2_PCQ
K2_PCQ_D:
    s_mov_b64 exec, -1
    s_mov_b32 m0, s23
    s_add_u32 s25, s20, 15360
    buffer_load_dwordx4 v2, s[12:15], s20 offen sc1 lds
    s_add_u32 s27, s20, 30720
    buffer_load_dwordx4 v3, s[12:15], s25 offen offset:1024 sc1 lds
    s_add_u32 s25, s20, 46080
    buffer_load_dwordx4 v2, s[12:15], s27 offen offset:2048 sc1 lds
    s_add_u32 s20, s20, 0x40000
    buffer_load_dwordx4 v3, s[12:15], s25 offen offset:3072 sc1 lds
    s_add_u32 s23, s23, 16384
    buffer_load_dword v247, v13, s[12:15], 0 offen sc1
    s_mov_b32 m0, s23
    s_add_u32 s25, s20, 15360
    buffer_load_dwordx4 v2, s[12:15], s20 offen sc1 lds
    s_add_u32 s27, s20, 30720
    buffer_load_dwordx4 v3, s[12:15], s25 offen offset:1024 sc1 lds
    s_add_u32 s25, s20, 46080
    buffer_load_dwordx4 v2, s[12:15], s27 offen offset:2048 sc1 lds
    s_add_u32 s20, s20, 0x40000
    buffer_load_dwordx4 v3, s[12:15], s25 offen offset:3072 sc1 lds
    s_sub_u32 s23, s23, 32768
    s_mov_b32 m0, s23
    s_add_u32 s25, s20, 15360
    buffer_load_dwordx4 v2, s[12:15], s20 offen sc1 lds
    s_add_u32 s27, s20, 30720
    buffer_load_dwordx4 v3, s[12:15], s25 offen offset:1024 sc1 lds
    s_add_u32 s25, s20, 46080
    buffer_load_dwordx4 v2, s[12:15], s27 offen offset:2048 sc1 lds
    s_add_u32 s20, s20, 0x40000
    buffer_load_dwordx4 v3, s[12:15], s25 offen offset:3072 sc1 lds
    s_add_u32 s23, s23, 16384
    s_waitcnt vmcnt(9)
    s_barrier
    s_waitcnt vmcnt(8)
    s_cmp_eq_u32 s53, 1
    s_cbranch_scc1 K2_VDQ
    v_cmp_ne_u32 vcc, s54, v247
    s_cbranch_vccz K2_VEQ
    s_mov_b32 s52, 0
K2_VPQ:
    buffer_load_dword v6, v13, s[12:15], 0 offen sc1
    s_add_u32 s52, s52, 1
    s_waitcnt vmcnt(0)
    v_cmp_ne_u32 vcc, s54, v6
    s_cmp_lt_u32 s52, 0x40000
    s_cbranch_vccz K2_VPQ_D
    s_mov_b64 exec, vcc
    s_sleep 4
    s_cbranch_scc1 K2_VPQ
K2_VPQ_D:
    s_mov_b64 exec, -1
K2_VEQ:
    buffer_load_dwordx4 v[16:19], v4, s[12:15], s30 offen sc1
    s_add_u32 s30, s30, 4096
    buffer_load_dwordx4 v[20:23], v4, s[12:15], s30 offen sc1
    s_add_u32 s30, s30, 4096
    buffer_load_dwordx4 v[24:27], v4, s[12:15], s30 offen sc1
    s_add_u32 s30, s30, 4096
    buffer_load_dwordx4 v[28:31], v4, s[12:15], s30 offen sc1
    s_add_u32 s30, s30, 4096
    buffer_load_dwordx4 v[32:35], v4, s[12:15], s30 offen sc1
    s_add_u32 s30, s30, 4096
    buffer_load_dwordx4 v[36:39], v4, s[12:15], s30 offen sc1
    s_add_u32 s30, s30, 4096
    buffer_load_dwordx4 v[40:43], v4, s[12:15], s30 offen sc1
    s_add_u32 s30, s30, 4096
    buffer_load_dwordx4 v[44:47], v4, s[12:15], s30 offen sc1
    s_add_u32 s30, s30, 4096
    buffer_load_dwordx4 v[48:51], v4, s[12:15], s30 offen sc1
    s_add_u32 s30, s30, 4096
    buffer_load_dwordx4 v[52:55], v4, s[12:15], s30 offen sc1
    s_add_u32 s30, s30, 4096
    buffer_load_dwordx4 v[56:59], v4, s[12:15], s30 offen sc1
    s_add_u32 s30, s30, 4096
    buffer_load_dwordx4 v[60:63], v4, s[12:15], s30 offen sc1
    s_add_u32 s30, s30, 4096
    buffer_load_dwordx4 v[64:67], v4, s[12:15], s30 offen sc1
    s_add_u32 s30, s30, 4096
    buffer_load_dwordx4 v[68:71], v4, s[12:15], s30 offen sc1
    s_add_u32 s30, s30, 4096
    buffer_load_dwordx4 v[72:75], v4, s[12:15], s30 offen sc1
    s_add_u32 s30, s30, 4096
    buffer_load_dwordx4 v[76:79], v4, s[12:15], s30 offen sc1
    s_add_u32 s30, s30, 4096
    buffer_load_dwordx4 v[80:83], v4, s[12:15], s30 offen sc1
    s_add_u32 s30, s30, 4096
    buffer_load_dwordx4 v[84:87], v4, s[12:15], s30 offen sc1
    s_add_u32 s30, s30, 4096
    buffer_load_dwordx4 v[88:91], v4, s[12:15], s30 offen sc1
    s_add_u32 s30, s30, 4096
    buffer_load_dwordx4 v[92:95], v4, s[12:15], s30 offen sc1
    s_add_u32 s30, s30, 4096
    buffer_load_dwordx4 v[96:99], v4, s[12:15], s30 offen sc1
    s_add_u32 s30, s30, 4096
    buffer_load_dwordx4 v[100:103], v4, s[12:15], s30 offen sc1
    s_add_u32 s30, s30, 4096
    buffer_load_dwordx4 v[104:107], v4, s[12:15], s30 offen sc1
    s_add_u32 s30, s30, 4096
    buffer_load_dwordx4 v[108:111], v4, s[12:15], s30 offen sc1
    s_add_u32 s30, s30, 4096
    buffer_load_dwordx4 v[112:115], v4, s[12:15], s30 offen sc1
    s_add_u32 s30, s30, 4096
    buffer_load_dwordx4 v[116:119], v4, s[12:15], s30 offen sc1
    s_add_u32 s30, s30, 4096
    buffer_load_dwordx4 v[120:123], v4, s[12:15], s29 offen offset:0 sc1
    buffer_load_dwordx4 v[124:127], v4, s[12:15], s29 offen offset:1024 sc1
    buffer_load_dwordx4 v[128:131], v4, s[12:15], s29 offen offset:2048 sc1
    buffer_load_dwordx4 v[132:135], v4, s[12:15], s29 offen offset:3072 sc1
    s_add_u32 s29, s29, 4096
K2_VDQ:
    buffer_load_dwordx4 v[136:139], v4, s[12:15], s29 offen offset:0 sc1
    buffer_load_dwordx4 v[140:143], v4, s[12:15], s29 offen offset:1024 sc1
    buffer_load_dwordx4 v[144:147], v4, s[12:15], s29 offen offset:2048 sc1
    buffer_load_dwordx4 v[148:151], v4, s[12:15], s29 offen offset:3072 sc1
    s_add_u32 s29, s29, 4096
    buffer_load_dwordx4 v[152:155], v4, s[12:15], s29 offen offset:0 sc1
    buffer_load_dwordx4 v[156:159], v4, s[12:15], s29 offen offset:1024 sc1
    buffer_load_dwordx4 v[160:163], v4, s[12:15], s29 offen offset:2048 sc1
    buffer_load_dwordx4 v[164:167], v4, s[12:15], s29 offen offset:3072 sc1
    s_add_u32 s29, s29, 4096
    s_waitcnt vmcnt(12)
    s_barrier
    s_mov_b32 m0, s23
    s_add_u32 s25, s20, 15360
    buffer_load_dwordx4 v2, s[12:15], s20 offen sc1 lds
    s_add_u32 s27, s20, 30720
    buffer_load_dwordx4 v3, s[12:15], s25 offen offset:1024 sc1 lds
    s_add_u32 s25, s20, 46080
    buffer_load_dwordx4 v2, s[12:15], s27 offen offset:2048 sc1 lds
    s_add_u32 s20, s20, 0x40000
    buffer_load_dwordx4 v3, s[12:15], s25 offen offset:3072 sc1 lds
    s_mov_b32 m0, s24
    s_add_u32 s25, s21, 4096
    buffer_load_dwordx4 v4, s[12:15], s21 offen offset:0 sc1 lds
    buffer_load_dwordx4 v4, s[12:15], s21 offen offset:1024 sc1 lds
    buffer_load_dwordx4 v4, s[12:15], s21 offen offset:2048 sc1 lds
    buffer_load_dwordx4 v4, s[12:15], s21 offen offset:3072 sc1 lds
    s_add_u32 m0, s24, 4096
    s_add_u32 s21, s21, 28672
    buffer_load_dwordx4 v4, s[12:15], s25 offen offset:0 sc1 lds
    buffer_load_dwordx4 v4, s[12:15], s25 offen offset:1024 sc1 lds
    buffer_load_dwordx4 v246, s[12:15], s25 offen offset:2048 sc1 lds
    buffer_load_dwordx4 v[168:171], v4, s[12:15], s29 offen offset:0 sc1
    buffer_load_dwordx4 v[172:175], v4, s[12:15], s29 offen offset:1024 sc1
    s_add_u32 s23, s23, 16384
    s_add_u32 s24, s24, 28672
    s_waitcnt vmcnt(21)
    s_barrier
    s_mov_b32 m0, s23
    s_add_u32 s25, s20, 15360
    buffer_load_dwordx4 v2, s[12:15], s20 offen sc1 lds
    s_add_u32 s27, s20, 30720
    buffer_load_dwordx4 v3, s[12:15], s25 offen offset:1024 sc1 lds
    s_add_u32 s25, s20, 46080
    buffer_load_dwordx4 v2, s[12:15], s27 offen offset:2048 sc1 lds
    s_add_u32 s20, s20, 0x40000
    buffer_load_dwordx4 v3, s[12:15], s25 offen offset:3072 sc1 lds
    s_mov_b32 m0, s24
    s_add_u32 s25, s21, 4096
    buffer_load_dwordx4 v4, s[12:15], s21 offen offset:0 sc1 lds
    buffer_load_dwordx4 v4, s[12:15], s21 offen offset:1024 sc1 lds
    buffer_load_dwordx4 v4, s[12:15], s21 offen offset:2048 sc1 lds
    buffer_load_dwordx4 v4, s[12:15], s21 offen offset:3072 sc1 lds
    s_add_u32 m0, s24, 4096
    s_add_u32 s21, s21, 28672
    buffer_load_dwordx4 v4, s[12:15], s25 offen offset:0 sc1 lds
    buffer_load_dwordx4 v4, s[12:15], s25 offen offset:1024 sc1 lds
    buffer_load_dwordx4 v246, s[12:15], s25 offen offset:2048 sc1 lds
    buffer_load_dwordx4 v[176:179], v4, s[12:15], s29 offen offset:2048 sc1
    s_add_u32 s29, s29, 49152
    buffer_load_dwordx4 v[180:183], v4, s[12:15], s29 offen offset:0 sc1
    s_sub_u32 s23, s23, 32768
    s_sub_u32 s24, s24, 57344
    s_waitcnt vmcnt(15)
    s_barrier
    s_mov_b32 m0, s23
    s_add_u32 s25, s20, 15360
    buffer_load_dwordx4 v2, s[12:15], s20 offen sc1 lds
    s_add_u32 s27, s20, 30720
    buffer_load_dwordx4 v3, s[12:15], s25 offen offset:1024 sc1 lds
    s_add_u32 s25, s20, 46080
    buffer_load_dwordx4 v2, s[12:15], s27 offen offset:2048 sc1 lds
    s_add_u32 s20, s20, 0x40000
    buffer_load_dwordx4 v3, s[12:15], s25 offen offset:3072 sc1 lds
    s_mov_b32 m0, s24
    s_add_u32 s25, s21, 4096
    buffer_load_dwordx4 v4, s[12:15], s21 offen offset:0 sc1 lds
    buffer_load_dwordx4 v4, s[12:15], s21 offen offset:1024 sc1 lds
    buffer_load_dwordx4 v4, s[12:15], s21 offen offset:2048 sc1 lds
    buffer_load_dwordx4 v4, s[12:15], s21 offen offset:3072 sc1 lds
    s_add_u32 m0, s24, 4096
    s_add_u32 s21, s21, 28672
    buffer_load_dwordx4 v4, s[12:15], s25 offen offset:0 sc1 lds
    buffer_load_dwordx4 v4, s[12:15], s25 offen offset:1024 sc1 lds
    buffer_load_dwordx4 v246, s[12:15], s25 offen offset:2048 sc1 lds
    buffer_load_dwordx4 v[184:187], v4, s[12:15], s29 offen offset:1024 sc1
    s_add_u32 s23, s23, 16384
    s_add_u32 s24, s24, 28672
    s_waitcnt vmcnt(14)
    s_barrier
    s_mov_b32 m0, s23
    s_add_u32 s25, s20, 15360
    buffer_load_dwordx4 v2, s[12:15], s20 offen sc1 lds
    s_add_u32 s27, s20, 30720
    buffer_load_dwordx4 v3, s[12:15], s25 offen offset:1024 sc1 lds
    s_add_u32 s25, s20, 46080
    buffer_load_dwordx4 v2, s[12:15], s27 offen offset:2048 sc1 lds
    s_add_u32 s20, s20, 0x40000
    buffer_load_dwordx4 v3, s[12:15], s25 offen offset:3072 sc1 lds
    s_mov_b32 m0, s24
    s_add_u32 s25, s21, 4096
    buffer_load_dwordx4 v4, s[12:15], s21 offen offset:0 sc1 lds
    buffer_load_dwordx4 v4, s[12:15], s21 offen offset:1024 sc1 lds
    buffer_load_dwordx4 v4, s[12:15], s21 offen offset:2048 sc1 lds
    buffer_load_dwordx4 v4, s[12:15], s21 offen offset:3072 sc1 lds
    s_add_u32 m0, s24, 4096
    s_add_u32 s21, s21, 28672
    buffer_load_dwordx4 v4, s[12:15], s25 offen offset:0 sc1 lds
    buffer_load_dwordx4 v4, s[12:15], s25 offen offset:1024 sc1 lds
    buffer_load_dwordx4 v246, s[12:15], s25 offen offset:2048 sc1 lds
    s_add_u32 s23, s23, 16384
    s_add_u32 s24, s24, 28672
    s_waitcnt vmcnt(12)
    s_barrier
    s_mov_b32 m0, s23
    s_add_u32 s25, s20, 15360
    buffer_load_dwordx4 v2, s[12:15], s20 offen sc1 lds
    s_add_u32 s27, s20, 30720
    buffer_load_dwordx4 v3, s[12:15], s25 offen offset:1024 sc1 lds
    s_add_u32 s25, s20, 46080
    buffer_load_dwordx4 v2, s[12:15], s27 offen offset:2048 sc1 lds
    s_add_u32 s20, s20, 0x40000
    buffer_load_dwordx4 v3, s[12:15], s25 offen offset:3072 sc1 lds
    s_mov_b32 m0, s24
    s_add_u32 s25, s21, 4096
    buffer_load_dwordx4 v4, s[12:15], s21 offen offset:0 sc1 lds
    buffer_load_dwordx4 v4, s[12:15], s21 offen offset:1024 sc1 lds
    buffer_load_dwordx4 v4, s[12:15], s21 offen offset:2048 sc1 lds
    buffer_load_dwordx4 v4, s[12:15], s21 offen offset:3072 sc1 lds
    s_add_u32 m0, s24, 4096
    s_add_u32 s21, s21, 28672
    buffer_load_dwordx4 v4, s[12:15], s25 offen offset:0 sc1 lds
    buffer_load_dwordx4 v4, s[12:15], s25 offen offset:1024 sc1 lds
    buffer_load_dwordx4 v246, s[12:15], s25 offen offset:2048 sc1 lds
    s_sub_u32 s23, s23, 32768
    s_sub_u32 s24, s24, 57344
    s_waitcnt vmcnt(11)
    s_barrier
    s_mov_b32 m0, s23
    s_add_u32 s25, s20, 15360
    buffer_load_dwordx4 v2, s[12:15], s20 offen sc1 lds
    s_add_u32 s27, s20, 30720
    buffer_load_dwordx4 v3, s[12:15], s25 offen offset:1024 sc1 lds
    s_add_u32 s25, s20, 46080
    buffer_load_dwordx4 v2, s[12:15], s27 offen offset:2048 sc1 lds
    s_add_u32 s20, s20, 0x40000
    buffer_load_dwordx4 v3, s[12:15], s25 offen offset:3072 sc1 lds
    s_mov_b32 m0, s24
    s_add_u32 s25, s21, 4096
    buffer_load_dwordx4 v4, s[12:15], s21 offen offset:0 sc1 lds
    buffer_load_dwordx4 v4, s[12:15], s21 offen offset:1024 sc1 lds
    buffer_load_dwordx4 v4, s[12:15], s21 offen offset:2048 sc1 lds
    buffer_load_dwordx4 v4, s[12:15], s21 offen offset:3072 sc1 lds
    s_add_u32 m0, s24, 4096
    s_add_u32 s21, s21, 28672
    buffer_load_dwordx4 v4, s[12:15], s25 offen offset:0 sc1 lds
    buffer_load_dwordx4 v4, s[12:15], s25 offen offset:1024 sc1 lds
    buffer_load_dwordx4 v246, s[12:15], s25 offen offset:2048 sc1 lds
    s_add_u32 s23, s23, 16384
    s_add_u32 s24, s24, 28672
    s_waitcnt vmcnt(11)
    s_barrier
    s_mov_b32 m0, s23
    s_add_u32 s25, s20, 15360
    buffer_load_dwordx4 v2, s[12:15], s20 offen sc1 lds
    s_add_u32 s27, s20, 30720
    buffer_load_dwordx4 v3, s[12:15], s25 offen offset:1024 sc1 lds
    s_add_u32 s25, s20, 46080
    buffer_load_dwordx4 v2, s[12:15], s27 offen offset:2048 sc1 lds
    s_add_u32 s20, s20, 0x40000
    buffer_load_dwordx4 v3, s[12:15], s25 offen offset:3072 sc1 lds
    s_add_u32 m0, s24, 4096
    s_add_u32 s25, s21, 4096
    buffer_load_dwordx4 v4, s[12:15], s25 offen offset:1024 sc1 lds
    buffer_load_dwordx4 v246, s[12:15], s25 offen offset:2048 sc1 lds
    s_mov_b32 m0, s24
    s_nop 0
    buffer_load_dwordx4 v4, s[12:15], s21 offen offset:2048 sc1 lds
    s_waitcnt vmcnt(7)
    s_barrier
    buffer_load_dwordx4 v4, s[12:15], s21 offen offset:0 sc1 lds
    buffer_load_dwordx4 v4, s[12:15], s21 offen offset:1024 sc1 lds
    buffer_load_dwordx4 v4, s[12:15], s21 offen offset:3072 sc1 lds
    s_add_u32 m0, s24, 4096
    s_nop 0
    buffer_load_dwordx4 v4, s[12:15], s25 offen offset:0 sc1 lds
    s_add_u32 s24, s24, 28672
    s_waitcnt vmcnt(4)
    s_barrier
    buffer_load_dwordx4 v[188:191], v4, s[12:15], s29 offen offset:2048 sc1
    buffer_load_dwordx4 v[192:195], v4, s[12:15], s29 offen offset:3072 sc1
    s_add_u32 s29, s29, 4096
    buffer_load_dwordx4 v[196:199], v4, s[12:15], s29 offen offset:0 sc1
    buffer_load_dwordx4 v[200:203], v4, s[12:15], s29 offen offset:1024 sc1
    buffer_load_dwordx4 v[204:207], v4, s[12:15], s29 offen offset:2048 sc1
    buffer_load_dwordx4 v[208:211], v4, s[12:15], s29 offen offset:3072 sc1
    s_add_u32 s29, s29, 4096
    buffer_load_dwordx4 v[212:215], v4, s[12:15], s29 offen offset:0 sc1
    buffer_load_dwordx4 v[216:219], v4, s[12:15], s29 offen offset:1024 sc1
    buffer_load_dwordx4 v[220:223], v4, s[12:15], s29 offen offset:2048 sc1
    buffer_load_dwordx4 v[224:227], v4, s[12:15], s29 offen offset:3072 sc1
    s_add_u32 s29, s29, 4096
    buffer_load_dwordx4 v[228:231], v4, s[12:15], s29 offen offset:0 sc1
    buffer_load_dwordx4 v[232:235], v4, s[12:15], s29 offen offset:1024 sc1
    s_waitcnt vmcnt(12)
    s_barrier
    buffer_load_dwordx4 v[236:239], v4, s[12:15], s29 offen offset:2048 sc1
    s_add_u32 m0, s42, 0
    s_add_u32 s25, s35, m0
    buffer_load_dwordx4 v4, s[12:15], s25 offen sc1 lds
    s_add_u32 m0, s42, 4096
    s_add_u32 s25, s35, m0
    buffer_load_dwordx4 v4, s[12:15], s25 offen sc1 lds
    s_add_u32 m0, s42, 8192
    s_add_u32 s25, s35, m0
    buffer_load_dwordx4 v4, s[12:15], s25 offen sc1 lds
    s_add_u32 m0, s42, 12288
    s_add_u32 s25, s35, m0
    buffer_load_dwordx4 v4, s[12:15], s25 offen sc1 lds
    s_add_u32 m0, s41, 0
    s_add_u32 s25, s40, 0
    buffer_load_dwordx4 v242, s[12:15], s25 offen sc1 lds
    s_add_u32 m0, s41, 4096
    s_add_u32 s25, s40, 131072
    buffer_load_dwordx4 v242, s[12:15], s25 offen sc1 lds
    s_cmp_lt_u32 s4, 2
    s_cbranch_scc0 K2_LRQ
    s_add_u32 m0, s42, 16384
    s_add_u32 s25, s35, m0
    buffer_load_dwordx4 v4, s[12:15], s25 offen sc1 lds
    s_branch K2_LSQ
K2_LRQ:
    s_add_u32 m0, s41, 6144
    s_add_u32 s25, s40, 196608
    buffer_load_dwordx4 v242, s[12:15], s25 offen sc1 lds
K2_LSQ:
    s_waitcnt vmcnt(63)
    s_barrier
    ds_write_b128 v244, v[16:19] offset:0
    s_mov_b32 m0, s24
    s_add_u32 s25, s35, s24
    buffer_load_dwordx4 v4, s[12:15], s25 offen sc1 lds
    ds_write_b128 v244, v[20:23] offset:4096
    buffer_load_dwordx4 v4, s[12:15], s25 offen offset:1024 sc1 lds
    ds_write_b128 v244, v[24:27] offset:8192
    buffer_load_dwordx4 v4, s[12:15], s25 offen offset:2048 sc1 lds
    ds_write_b128 v244, v[28:31] offset:12288
    buffer_load_dwordx4 v4, s[12:15], s25 offen offset:3072 sc1 lds
    ds_write_b128 v244, v[32:35] offset:16384
    s_add_u32 m0, s24, 4096
    s_add_u32 s25, s25, 4096
    buffer_load_dwordx4 v4, s[12:15], s25 offen sc1 lds
    ds_write_b128 v244, v[36:39] offset:20480
    buffer_load_dwordx4 v4, s[12:15], s25 offen offset:1024 sc1 lds
    ds_write_b128 v244, v[40:43] offset:24576
    buffer_load_dwordx4 v4, s[12:15], s25 offen offset:2048 sc1 lds
    ds_write_b128 v244, v[44:47] offset:28672
    ds_write_b128 v244, v[48:51] offset:32768
    ds_write_b128 v244, v[52:55] offset:36864
    ds_write_b128 v244, v[56:59] offset:40960
    ds_write_b128 v244, v[60:63] offset:45056
    ds_write_b128 v244, v[64:67] offset:49152
    s_waitcnt vmcnt(63)
    ds_write_b128 v244, v[68:71] offset:53248
    ds_write_b128 v244, v[72:75] offset:57344
    ds_write_b128 v244, v[76:79] offset:61440
    ds_write_b128 v245, v[80:83] offset:0
    ds_write_b128 v245, v[84:87] offset:4096
    ds_write_b128 v245, v[88:91] offset:8192
    ds_write_b128 v245, v[92:95] offset:12288
    buffer_load_dword v11, v241, s[12:15], s38 offen sc1
    ds_write_b128 v245, v[96:99] offset:16384
    ds_write_b128 v245, v[100:103] offset:20480
    ds_write_b128 v245, v[104:107] offset:24576
    ds_write_b128 v245, v[108:111] offset:28672
    ds_write_b128 v245, v[112:115] offset:32768
    ds_write_b128 v245, v[116:119] offset:36864
    s_waitcnt vmcnt(0) lgkmcnt(0)
    v_cmp_ne_u32 vcc, s54, v11
    s_cbranch_vccz K2_PAQ_OK
    s_mov_b32 s52, 0
K2_PAQ:
    buffer_load_dword v11, v241, s[12:15], s38 offen sc1
    s_add_u32 s52, s52, 1
    s_waitcnt vmcnt(0)
    v_cmp_ne_u32 vcc, s54, v11
    s_cmp_lt_u32 s52, 0x40000
    s_cbranch_vccz K2_PAQ_D
    s_mov_b64 exec, vcc
    s_sleep 4
    s_cbranch_scc1 K2_PAQ
K2_PAQ_D:
    s_mov_b64 exec, -1
K2_PAQ_OK:
    s_barrier
    s_waitcnt vmcnt(0) lgkmcnt(0)
    s_barrier
    buffer_load_dword v11, v241, s[12:15], s39 offen sc1
    ds_write_b128 v240, v[120:123] offset:0
    ds_write_b128 v240, v[124:127] offset:1024
    ds_write_b128 v240, v[128:131] offset:2048
    ds_write_b128 v240, v[132:135] offset:3072
    s_waitcnt vmcnt(0)
    v_cmp_ne_u32 vcc, s54, v11
    s_cbranch_vccz K2_PBQ_OK
    s_mov_b32 s52, 0
K2_PBQ:
    buffer_load_dword v11, v241, s[12:15], s39 offen sc1
    s_add_u32 s52, s52, 1
    s_waitcnt vmcnt(0)
    v_cmp_ne_u32 vcc, s54, v11
    s_cmp_lt_u32 s52, 0x40000
    s_cbranch_vccz K2_PBQ_D
    s_mov_b64 exec, vcc
    s_sleep 4
    s_cbranch_scc1 K2_PBQ
K2_PBQ_D:
    s_mov_b64 exec, -1
K2_PBQ_OK:
    s_barrier
    ds_write_b128 v240, v[136:139] offset:4096
    ds_write_b128 v240, v[140:143] offset:5120
    ds_write_b128 v240, v[144:147] offset:6144
    ds_write_b128 v240, v[148:151] offset:7168
    ds_write_b128 v240, v[152:155] offset:8192
    ds_write_b128 v240, v[156:159] offset:9216
    ds_write_b128 v240, v[160:163] offset:10240
    ds_write_b128 v240, v[164:167] offset:11264
    ds_write_b128 v240, v[168:171] offset:12288
    ds_write_b128 v240, v[172:175] offset:13312
    ds_write_b128 v240, v[176:179] offset:14336
    s_waitcnt lgkmcnt(0)
    s_barrier
    s_waitcnt vmcnt(0)
    ds_write_b128 v243, v[180:183] offset:0
    ds_write_b128 v243, v[184:187] offset:1024
    ds_write_b128 v243, v[188:191] offset:2048
    ds_write_b128 v243, v[192:195] offset:3072
    ds_write_b128 v243, v[196:199] offset:4096
    ds_write_b128 v243, v[200:203] offset:5120
    ds_write_b128 v243, v[204:207] offset:6144
    ds_write_b128 v243, v[208:211] offset:7168
    ds_write_b128 v243, v[212:215] offset:8192
    ds_write_b128 v243, v[216:219] offset:9216
    ds_write_b128 v243, v[220:223] offset:10240
    ds_write_b128 v243, v[224:227] offset:11264
    ds_write_b128 v243, v[228:231] offset:12288
    ds_write_b128 v243, v[232:235] offset:13312
    ds_write_b128 v243, v[236:239] offset:14336
    s_waitcnt lgkmcnt(0)
    s_barrier
    s_endpgm
K2_LOADER:
    s_mov_b32 s53, 0
    s_waitcnt vmcnt(0)
    v_cmp_ne_u32 vcc, s54, v6
    s_cbranch_vccnz K2_FENO
    s_mov_b32 s53, 1
    s_mov_b32 m0, s24
    s_add_u32 s25, s21, 4096
    buffer_load_dwordx4 v4, s[12:15], s21 offen offset:0 sc1 lds
    buffer_load_dwordx4 v4, s[12:15], s21 offen offset:1024 sc1 lds
    buffer_load_dwordx4 v4, s[12:15], s21 offen offset:2048 sc1 lds
    buffer_load_dwordx4 v4, s[12:15], s21 offen offset:3072 sc1 lds
    s_add_u32 m0, s24, 4096
    s_add_u32 s21, s21, 28672
    buffer_load_dwordx4 v4, s[12:15], s25 offen offset:0 sc1 lds
    buffer_load_dwordx4 v4, s[12:15], s25 offen offset:1024 sc1 lds
    buffer_load_dwordx4 v246, s[12:15], s25 offen offset:2048 sc1 lds
    s_add_u32 s24, s24, 28672
    s_mov_b32 m0, s24
    s_add_u32 s25, s21, 4096
    buffer_load_dwordx4 v4, s[12:15], s21 offen offset:0 sc1 lds
    buffer_load_dwordx4 v4, s[12:15], s21 offen offset:1024 sc1 lds
    buffer_load_dwordx4 v4, s[12:15], s21 offen offset:2048 sc1 lds
    buffer_load_dwordx4 v4, s[12:15], s21 offen offset:3072 sc1 lds
    s_add_u32 m0, s24, 4096
    s_add_u32 s21, s21, 28672
    buffer_load_dwordx4 v4, s[12:15], s25 offen offset:0 sc1 lds
    buffer_load_dwordx4 v4, s[12:15], s25 offen offset:1024 sc1 lds
    buffer_load_dwordx4 v246, s[12:15], s25 offen offset:2048 sc1 lds
    s_sub_u32 s24, s24, 57344
K2_FENO:
    v_and_b32 v14, 31, v1
    v_lshlrev_b32 v14, 2, v14
    v_lshrrev_b32 v15, 5, v1
    v_mul_u32_u24 v12, 0x8000, v15
    v_add_u32 v12, v14, v12
    v_mul_u32_u24 v15, 0x18000, v15
    v_add_u32 v14, v14, v15
    v_mov_b32 v15, s54
    s_lshl_b32 s3, s57, 7
    s_add_u32 s43, s3, 0x1860000
    s_add_u32 s3, s3, 0x1888000
    s_waitcnt lgkmcnt(0)
    s_barrier
    s_cmp_eq_u32 s53, 1
    s_cselect_b64 vcc, -1, 0
    s_mov_b32 s44, 0
    s_nop 0
    v_cndmask_b32 v9, v10, v13, vcc
    buffer_load_dword v6, v9, s[12:15], 0 offen sc1
    s_waitcnt vmcnt(0)
    v_cmp_ne_u32 vcc, s54, v6
    s_cmp_lg_u32 s4, 0
    s_barrier
    s_cbranch_scc1 K2_NOFA
    buffer_store_dword v15, v12, s[12:15], s3 offen sc1
K2_NOFA:
    s_cbranch_vccnz K2_PNO
    s_cmp_eq_u32 s53, 1
    s_cbranch_scc1 K2_PWD
    s_mov_b32 s53, 1
    s_mov_b32 m0, s24
    s_add_u32 s25, s21, 4096
    buffer_load_dwordx4 v4, s[12:15], s21 offen offset:0 sc1 lds
    buffer_load_dwordx4 v4, s[12:15], s21 offen offset:1024 sc1 lds
    buffer_load_dwordx4 v4, s[12:15], s21 offen offset:2048 sc1 lds
    buffer_load_dwordx4 v4, s[12:15], s21 offen offset:3072 sc1 lds
    s_add_u32 m0, s24, 4096
    s_add_u32 s21, s21, 28672
    buffer_load_dwordx4 v4, s[12:15], s25 offen offset:0 sc1 lds
    buffer_load_dwordx4 v4, s[12:15], s25 offen offset:1024 sc1 lds
    buffer_load_dwordx4 v246, s[12:15], s25 offen offset:2048 sc1 lds
    s_add_u32 s24, s24, 28672
    s_mov_b32 m0, s24
    s_add_u32 s25, s21, 4096
    buffer_load_dwordx4 v4, s[12:15], s21 offen offset:0 sc1 lds
    buffer_load_dwordx4 v4, s[12:15], s21 offen offset:1024 sc1 lds
    buffer_load_dwordx4 v4, s[12:15], s21 offen offset:2048 sc1 lds
    buffer_load_dwordx4 v4, s[12:15], s21 offen offset:3072 sc1 lds
    s_add_u32 m0, s24, 4096
    s_add_u32 s21, s21, 28672
    buffer_load_dwordx4 v4, s[12:15], s25 offen offset:0 sc1 lds
    buffer_load_dwordx4 v4, s[12:15], s25 offen offset:1024 sc1 lds
    buffer_load_dwordx4 v246, s[12:15], s25 offen offset:2048 sc1 lds
    s_sub_u32 s24, s24, 57344
    s_branch K2_PNO
K2_PWD:
    s_mov_b32 s44, 1
    buffer_load_dwordx4 v[16:19], v4, s[12:15], s30 offen sc1
    s_add_u32 s30, s30, 4096
    buffer_load_dwordx4 v[20:23], v4, s[12:15], s30 offen sc1
    s_add_u32 s30, s30, 4096
    buffer_load_dwordx4 v[24:27], v4, s[12:15], s30 offen sc1
    s_add_u32 s30, s30, 4096
    buffer_load_dwordx4 v[28:31], v4, s[12:15], s30 offen sc1
    s_add_u32 s30, s30, 4096
    buffer_load_dwordx4 v[32:35], v4, s[12:15], s30 offen sc1
    s_add_u32 s30, s30, 4096
    buffer_load_dwordx4 v[36:39], v4, s[12:15], s30 offen sc1
    s_add_u32 s30, s30, 4096
    buffer_load_dwordx4 v[40:43], v4, s[12:15], s30 offen sc1
    s_add_u32 s30, s30, 4096
    buffer_load_dwordx4 v[44:47], v4, s[12:15], s30 offen sc1
    s_add_u32 s30, s30, 4096
    buffer_load_dwordx4 v[48:51], v4, s[12:15], s30 offen sc1
    s_add_u32 s30, s30, 4096
    buffer_load_dwordx4 v[52:55], v4, s[12:15], s30 offen sc1
    s_add_u32 s30, s30, 4096
    buffer_load_dwordx4 v[56:59], v4, s[12:15], s30 offen sc1
    s_add_u32 s30, s30, 4096
    buffer_load_dwordx4 v[60:63], v4, s[12:15], s30 offen sc1
    s_add_u32 s30, s30, 4096
K2_PNO:
    s_cmp_lg_u32 s4, 0
    s_barrier
    s_cbranch_scc1 K2_NOFP
    buffer_store_dword v15, v14, s[12:15], s43 offen sc1
K2_NOFP:
    s_mov_b32 s52, 0
K2_PCP:
    buffer_load_dword v6, v7, s[12:15], 0 offen sc1
    s_add_u32 s52, s52, 1
    s_waitcnt vmcnt(0)
    v_cmp_ne_u32 vcc, s54, v6
    s_cmp_lt_u32 s52, 0x40000
    s_cbranch_vccz K2_PCP_D
    s_mov_b64 exec, vcc
    s_sleep 4
    s_cbranch_scc1 K2_PCP
K2_PCP_D:
    s_mov_b64 exec, -1
    s_cmp_eq_u32 s53, 1
    s_cbranch_scc1 K2_W01
    s_mov_b32 m0, s24
    s_add_u32 s25, s21, 4096
    buffer_load_dwordx4 v4, s[12:15], s21 offen offset:0 sc1 lds
    buffer_load_dwordx4 v4, s[12:15], s21 offen offset:1024 sc1 lds
    buffer_load_dwordx4 v4, s[12:15], s21 offen offset:2048 sc1 lds
    buffer_load_dwordx4 v4, s[12:15], s21 offen offset:3072 sc1 lds
    s_add_u32 m0, s24, 4096
    s_add_u32 s21, s21, 28672
    buffer_load_dwordx4 v4, s[12:15], s25 offen offset:0 sc1 lds
    buffer_load_dwordx4 v4, s[12:15], s25 offen offset:1024 sc1 lds
    buffer_load_dwordx4 v246, s[12:15], s25 offen offset:2048 sc1 lds
    s_add_u32 s24, s24, 28672
    s_mov_b32 m0, s24
    s_add_u32 s25, s21, 4096
    buffer_load_dwordx4 v4, s[12:15], s21 offen offset:0 sc1 lds
    buffer_load_dwordx4 v4, s[12:15], s21 offen offset:1024 sc1 lds
    buffer_load_dwordx4 v4, s[12:15], s21 offen offset:2048 sc1 lds
    buffer_load_dwordx4 v4, s[12:15], s21 offen offset:3072 sc1 lds
    s_add_u32 m0, s24, 4096
    s_add_u32 s21, s21, 28672
    buffer_load_dwordx4 v4, s[12:15], s25 offen offset:0 sc1 lds
    buffer_load_dwordx4 v4, s[12:15], s25 offen offset:1024 sc1 lds
    buffer_load_dwordx4 v246, s[12:15], s25 offen offset:2048 sc1 lds
    s_sub_u32 s24, s24, 57344
K2_W01:
    s_mov_b32 m0, s23
    s_add_u32 s25, s20, 15360
    buffer_load_dwordx4 v2, s[12:15], s20 offen sc1 lds
    s_add_u32 s27, s20, 30720
    buffer_load_dwordx4 v3, s[12:15], s25 offen offset:1024 sc1 lds
    s_add_u32 s25, s20, 46080
    buffer_load_dwordx4 v2, s[12:15], s27 offen offset:2048 sc1 lds
    s_add_u32 s20, s20, 0x40000
    buffer_load_dwordx4 v3, s[12:15], s25 offen offset:3072 sc1 lds
    s_add_u32 s23, s23, 16384
    s_mov_b32 m0, s23
    s_add_u32 s25, s20, 15360
    buffer_load_dwordx4 v2, s[12:15], s20 offen sc1 lds
    s_add_u32 s27, s20, 30720
    buffer_load_dwordx4 v3, s[12:15], s25 offen offset:1024 sc1 lds
    s_add_u32 s25, s20, 46080
    buffer_load_dwordx4 v2, s[12:15], s27 offen offset:2048 sc1 lds
    s_add_u32 s20, s20, 0x40000
    buffer_load_dwordx4 v3, s[12:15], s25 offen offset:3072 sc1 lds
    s_sub_u32 s23, s23, 32768
    s_waitcnt vmcnt(4)
    s_barrier
    s_mov_b32 m0, s23
    s_add_u32 s25, s20, 15360
    buffer_load_dwordx4 v2, s[12:15], s20 offen sc1 lds
    s_add_u32 s27, s20, 30720
    buffer_load_dwordx4 v3, s[12:15], s25 offen offset:1024 sc1 lds
    s_add_u32 s25, s20, 46080
    buffer_load_dwordx4 v2, s[12:15], s27 offen offset:2048 sc1 lds
    s_add_u32 s20, s20, 0x40000
    buffer_load_dwordx4 v3, s[12:15], s25 offen offset:3072 sc1 lds
    s_mov_b32 m0, s24
    s_add_u32 s25, s21, 4096
    buffer_load_dwordx4 v4, s[12:15], s21 offen offset:0 sc1 lds
    buffer_load_dwordx4 v4, s[12:15], s21 offen offset:1024 sc1 lds
    buffer_load_dwordx4 v4, s[12:15], s21 offen offset:2048 sc1 lds
    buffer_load_dwordx4 v4, s[12:15], s21 offen offset:3072 sc1 lds
    s_add_u32 m0, s24, 4096
    s_add_u32 s21, s21, 28672
    buffer_load_dwordx4 v4, s[12:15], s25 offen offset:0 sc1 lds
    buffer_load_dwordx4 v4, s[12:15], s25 offen offset:1024 sc1 lds
    buffer_load_dwordx4 v246, s[12:15], s25 offen offset:2048 sc1 lds
    s_add_u32 s23, s23, 16384
    s_add_u32 s24, s24, 28672
    s_mov_b32 s53, s44
    s_waitcnt vmcnt(11)
    s_barrier
    buffer_load_dword v247, v13, s[12:15], 0 offen sc1
    s_mov_b32 m0, s23
    s_add_u32 s25, s20, 15360
    buffer_load_dwordx4 v2, s[12:15], s20 offen sc1 lds
    s_add_u32 s27, s20, 30720
    buffer_load_dwordx4 v3, s[12:15], s25 offen offset:1024 sc1 lds
    s_add_u32 s25, s20, 46080
    buffer_load_dwordx4 v2, s[12:15], s27 offen offset:2048 sc1 lds
    s_add_u32 s20, s20, 0x40000
    buffer_load_dwordx4 v3, s[12:15], s25 offen offset:3072 sc1 lds
    s_mov_b32 m0, s24
    s_add_u32 s25, s21, 4096
    buffer_load_dwordx4 v4, s[12:15], s21 offen offset:0 sc1 lds
    buffer_load_dwordx4 v4, s[12:15], s21 offen offset:1024 sc1 lds
    buffer_load_dwordx4 v4, s[12:15], s21 offen offset:2048 sc1 lds
    buffer_load_dwordx4 v4, s[12:15], s21 offen offset:3072 sc1 lds
    s_add_u32 m0, s24, 4096
    s_add_u32 s21, s21, 28672
    buffer_load_dwordx4 v4, s[12:15], s25 offen offset:0 sc1 lds
    buffer_load_dwordx4 v4, s[12:15], s25 offen offset:1024 sc1 lds
    buffer_load_dwordx4 v246, s[12:15], s25 offen offset:2048 sc1 lds
    s_add_u32 s23, s23, 16384
    s_add_u32 s24, s24, 28672
    s_waitcnt vmcnt(12)
    s_barrier
    s_mov_b32 m0, s23
    s_add_u32 s25, s20, 15360
    buffer_load_dwordx4 v2, s[12:15], s20 offen sc1 lds
    s_add_u32 s27, s20, 30720
    buffer_load_dwordx4 v3, s[12:15], s25 offen offset:1024 sc1 lds
    s_add_u32 s25, s20, 46080
    buffer_load_dwordx4 v2, s[12:15], s27 offen offset:2048 sc1 lds
    s_add_u32 s20, s20, 0x40000
    buffer_load_dwordx4 v3, s[12:15], s25 offen offset:3072 sc1 lds
    s_mov_b32 m0, s24
    s_add_u32 s25, s21, 4096
    buffer_load_dwordx4 v4, s[12:15], s21 offen offset:0 sc1 lds
    buffer_load_dwordx4 v4, s[12:15], s21 offen offset:1024 sc1 lds
    buffer_load_dwordx4 v4, s[12:15], s21 offen offset:2048 sc1 lds
    buffer_load_dwordx4 v4, s[12:15], s21 offen offset:3072 sc1 lds
    s_add_u32 m0, s24, 4096
    s_add_u32 s21, s21, 28672
    buffer_load_dwordx4 v4, s[12:15], s25 offen offset:0 sc1 lds
    buffer_load_dwordx4 v4, s[12:15], s25 offen offset:1024 sc1 lds
    buffer_load_dwordx4 v246, s[12:15], s25 offen offset:2048 sc1 lds
    s_waitcnt vmcnt(22)
    s_cmp_eq_u32 s53, 1
    s_cbranch_scc1 K2_VDP
    v_cmp_ne_u32 vcc, s54, v247
    s_cbranch_vccz K2_VEP
    s_mov_b32 s52, 0
K2_VPP:
    buffer_load_dword v6, v13, s[12:15], 0 offen sc1
    s_add_u32 s52, s52, 1
    s_waitcnt vmcnt(0)
    v_cmp_ne_u32 vcc, s54, v6
    s_cmp_lt_u32 s52, 0x40000
    s_cbranch_vccz K2_VPP_D
    s_mov_b64 exec, vcc
    s_sleep 4
    s_cbranch_scc1 K2_VPP
K2_VPP_D:
    s_mov_b64 exec, -1
K2_VEP:
    buffer_load_dwordx4 v[16:19], v4, s[12:15], s30 offen sc1
    s_add_u32 s30, s30, 4096
    buffer_load_dwordx4 v[20:23], v4, s[12:15], s30 offen sc1
    s_add_u32 s30, s30, 4096
    buffer_load_dwordx4 v[24:27], v4, s[12:15], s30 offen sc1
    s_add_u32 s30, s30, 4096
    buffer_load_dwordx4 v[28:31], v4, s[12:15], s30 offen sc1
    s_add_u32 s30, s30, 4096
    buffer_load_dwordx4 v[32:35], v4, s[12:15], s30 offen sc1
    s_add_u32 s30, s30, 4096
    buffer_load_dwordx4 v[36:39], v4, s[12:15], s30 offen sc1
    s_add_u32 s30, s30, 4096
    buffer_load_dwordx4 v[40:43], v4, s[12:15], s30 offen sc1
    s_add_u32 s30, s30, 4096
    buffer_load_dwordx4 v[44:47], v4, s[12:15], s30 offen sc1
    s_add_u32 s30, s30, 4096
    buffer_load_dwordx4 v[48:51], v4, s[12:15], s30 offen sc1
    s_add_u32 s30, s30, 4096
    buffer_load_dwordx4 v[52:55], v4, s[12:15], s30 offen sc1
    s_add_u32 s30, s30, 4096
    buffer_load_dwordx4 v[56:59], v4, s[12:15], s30 offen sc1
    s_add_u32 s30, s30, 4096
    buffer_load_dwordx4 v[60:63], v4, s[12:15], s30 offen sc1
    s_add_u32 s30, s30, 4096
K2_VDP:
    buffer_load_dwordx4 v[64:67], v4, s[12:15], s30 offen sc1
    s_add_u32 s30, s30, 4096
    buffer_load_dwordx4 v[68:71], v4, s[12:15], s30 offen sc1
    s_add_u32 s30, s30, 4096
    buffer_load_dwordx4 v[72:75], v4, s[12:15], s30 offen sc1
    s_add_u32 s30, s30, 4096
    s_sub_u32 s23, s23, 32768
    s_sub_u32 s24, s24, 57344
    s_waitcnt vmcnt(14)
    s_barrier
    s_mov_b32 m0, s23
    s_add_u32 s25, s20, 15360
    buffer_load_dwordx4 v2, s[12:15], s20 offen sc1 lds
    s_add_u32 s27, s20, 30720
    buffer_load_dwordx4 v3, s[12:15], s25 offen offset:1024 sc1 lds
    s_add_u32 s25, s20, 46080
    buffer_load_dwordx4 v2, s[12:15], s27 offen offset:2048 sc1 lds
    s_add_u32 s20, s20, 0x40000
    buffer_load_dwordx4 v3, s[12:15], s25 offen offset:3072 sc1 lds
    s_mov_b32 m0, s24
    s_add_u32 s25, s21, 4096
    buffer_load_dwordx4 v4, s[12:15], s21 offen offset:0 sc1 lds
    buffer_load_dwordx4 v4, s[12:15], s21 offen offset:1024 sc1 lds
    buffer_load_dwordx4 v4, s[12:15], s21 offen offset:2048 sc1 lds
    buffer_load_dwordx4 v4, s[12:15], s21 offen offset:3072 sc1 lds
    s_add_u32 m0, s24, 4096
    s_add_u32 s21, s21, 28672
    buffer_load_dwordx4 v4, s[12:15], s25 offen offset:0 sc1 lds
    buffer_load_dwordx4 v4, s[12:15], s25 offen offset:1024 sc1 lds
    buffer_load_dwordx4 v246, s[12:15], s25 offen offset:2048 sc1 lds
    buffer_load_dwordx4 v[76:79], v4, s[12:15], s30 offen sc1
    s_add_u32 s30, s30, 4096
    buffer_load_dwordx4 v[80:83], v4, s[12:15], s30 offen sc1
    s_add_u32 s30, s30, 4096
    buffer_load_dwordx4 v[84:87], v4, s[12:15], s30 offen sc1
    s_add_u32 s30, s30, 4096
    s_add_u32 s23, s23, 16384
    s_add_u32 s24, s24, 28672
    s_waitcnt vmcnt(17)
    s_barrier
    s_mov_b32 m0, s23
    s_add_u32 s25, s20, 15360
    buffer_load_dwordx4 v2, s[12:15], s20 offen sc1 lds
    s_add_u32 s27, s20, 30720
    buffer_load_dwordx4 v3, s[12:15], s25 offen offset:1024 sc1 lds
    s_add_u32 s25, s20, 46080
    buffer_load_dwordx4 v2, s[12:15], s27 offen offset:2048 sc1 lds
    s_add_u32 s20, s20, 0x40000
    buffer_load_dwordx4 v3, s[12:15], s25 offen offset:3072 sc1 lds
    s_mov_b32 m0, s24
    s_add_u32 s25, s21, 4096
    buffer_load_dwordx4 v4, s[12:15], s21 offen offset:0 sc1 lds
    buffer_load_dwordx4 v4, s[12:15], s21 offen offset:1024 sc1 lds
    buffer_load_dwordx4 v4, s[12:15], s21 offen offset:2048 sc1 lds
    buffer_load_dwordx4 v4, s[12:15], s21 offen offset:3072 sc1 lds
    s_add_u32 m0, s24, 4096
    s_add_u32 s21, s21, 28672
    buffer_load_dwordx4 v4, s[12:15], s25 offen offset:0 sc1 lds
    buffer_load_dwordx4 v4, s[12:15], s25 offen offset:1024 sc1 lds
    buffer_load_dwordx4 v246, s[12:15], s25 offen offset:2048 sc1 lds
    buffer_load_dwordx4 v[88:91], v4, s[12:15], s30 offen sc1
    s_add_u32 s30, s30, 4096
    buffer_load_dwordx4 v[92:95], v4, s[12:15], s30 offen sc1
    s_add_u32 s30, s30, 4096
    buffer_load_dwordx4 v[96:99], v4, s[12:15], s30 offen sc1
    s_add_u32 s30, s30, 4096
    s_add_u32 s23, s23, 16384
    s_add_u32 s24, s24, 28672
    s_waitcnt vmcnt(17)
    s_barrier
    s_mov_b32 m0, s23
    s_add_u32 s25, s20, 15360
    buffer_load_dwordx4 v2, s[12:15], s20 offen sc1 lds
    s_add_u32 s27, s20, 30720
    buffer_load_dwordx4 v3, s[12:15], s25 offen offset:1024 sc1 lds
    s_add_u32 s25, s20, 46080
    buffer_load_dwordx4 v2, s[12:15], s27 offen offset:2048 sc1 lds
    s_add_u32 s20, s20, 0x40000
    buffer_load_dwordx4 v3, s[12:15], s25 offen offset:3072 sc1 lds
    s_mov_b32 m0, s24
    s_add_u32 s25, s21, 4096
    buffer_load_dwordx4 v4, s[12:15], s21 offen offset:0 sc1 lds
    buffer_load_dwordx4 v4, s[12:15], s21 offen offset:1024 sc1 lds
    buffer_load_dwordx4 v4, s[12:15], s21 offen offset:2048 sc1 lds
    buffer_load_dwordx4 v4, s[12:15], s21 offen offset:3072 sc1 lds
    s_add_u32 m0, s24, 4096
    s_add_u32 s21, s21, 28672
    buffer_load_dwordx4 v4, s[12:15], s25 offen offset:0 sc1 lds
    buffer_load_dwordx4 v4, s[12:15], s25 offen offset:1024 sc1 lds
    buffer_load_dwordx4 v246, s[12:15], s25 offen offset:2048 sc1 lds
    s_sub_u32 s23, s23, 32768
    s_sub_u32 s24, s24, 57344
    s_waitcnt vmcnt(14)
    s_barrier
    s_mov_b32 m0, s23
    s_add_u32 s25, s20, 15360
    buffer_load_dwordx4 v2, s[12:15], s20 offen sc1 lds
    s_add_u32 s27, s20, 30720
    buffer_load_dwordx4 v3, s[12:15], s25 offen offset:1024 sc1 lds
    s_add_u32 s25, s20, 46080
    buffer_load_dwordx4 v2, s[12:15], s27 offen offset:2048 sc1 lds
    s_add_u32 s20, s20, 0x40000
    buffer_load_dwordx4 v3, s[12:15], s25 offen offset:3072 sc1 lds
    s_mov_b32 m0, s24
    s_add_u32 s25, s21, 4096
    buffer_load_dwordx4 v4, s[12:15], s21 offen offset:0 sc1 lds
    buffer_load_dwordx4 v4, s[12:15], s21 offen offset:1024 sc1 lds
    buffer_load_dwordx4 v4, s[12:15], s21 offen offset:2048 sc1 lds
    buffer_load_dwordx4 v4, s[12:15], s21 offen offset:3072 sc1 lds
    s_add_u32 m0, s24, 4096
    s_add_u32 s21, s21, 28672
    buffer_load_dwordx4 v4, s[12:15], s25 offen offset:0 sc1 lds
    buffer_load_dwordx4 v4, s[12:15], s25 offen offset:1024 sc1 lds
    buffer_load_dwordx4 v246, s[12:15], s25 offen offset:2048 sc1 lds
    s_add_u32 s23, s23, 16384
    s_add_u32 s24, s24, 28672
    s_waitcnt vmcnt(11)
    s_barrier
    s_mov_b32 m0, s23
    s_add_u32 s25, s20, 15360
    buffer_load_dwordx4 v2, s[12:15], s20 offen sc1 lds
    s_add_u32 s27, s20, 30720
    buffer_load_dwordx4 v3, s[12:15], s25 offen offset:1024 sc1 lds
    s_add_u32 s25, s20, 46080
    buffer_load_dwordx4 v2, s[12:15], s27 offen offset:2048 sc1 lds
    s_add_u32 s20, s20, 0x40000
    buffer_load_dwordx4 v3, s[12:15], s25 offen offset:3072 sc1 lds
    s_add_u32 m0, s24, 4096
    s_add_u32 s25, s21, 4096
    buffer_load_dwordx4 v4, s[12:15], s25 offen offset:1024 sc1 lds
    buffer_load_dwordx4 v246, s[12:15], s25 offen offset:2048 sc1 lds
    s_mov_b32 m0, s24
    s_nop 0
    buffer_load_dwordx4 v4, s[12:15], s21 offen offset:2048 sc1 lds
    s_waitcnt vmcnt(7)
    s_barrier
    buffer_load_dwordx4 v4, s[12:15], s21 offen offset:0 sc1 lds
    buffer_load_dwordx4 v4, s[12:15], s21 offen offset:1024 sc1 lds
    buffer_load_dwordx4 v4, s[12:15], s21 offen offset:3072 sc1 lds
    s_add_u32 m0, s24, 4096
    s_nop 0
    buffer_load_dwordx4 v4, s[12:15], s25 offen offset:0 sc1 lds
    s_add_u32 s24, s24, 28672
    s_waitcnt vmcnt(4)
    s_barrier
    buffer_load_dwordx4 v[100:103], v4, s[12:15], s30 offen sc1
    s_add_u32 s30, s30, 4096
    buffer_load_dwordx4 v[104:107], v4, s[12:15], s30 offen sc1
    s_add_u32 s30, s30, 4096
    buffer_load_dwordx4 v[108:111], v4, s[12:15], s30 offen sc1
    s_add_u32 s30, s30, 4096
    buffer_load_dwordx4 v[112:115], v4, s[12:15], s30 offen sc1
    s_add_u32 s30, s30, 4096
    buffer_load_dwordx4 v[116:119], v4, s[12:15], s30 offen sc1
    s_add_u32 s30, s30, 4096
    buffer_load_dwordx4 v[120:123], v4, s[12:15], s29 offen offset:0 sc1
    buffer_load_dwordx4 v[124:127], v4, s[12:15], s29 offen offset:1024 sc1
    buffer_load_dwordx4 v[128:131], v4, s[12:15], s29 offen offset:2048 sc1
    buffer_load_dwordx4 v[132:135], v4, s[12:15], s29 offen offset:3072 sc1
    s_add_u32 s29, s29, 4096
    buffer_load_dwordx4 v[136:139], v4, s[12:15], s29 offen offset:0 sc1
    buffer_load_dwordx4 v[140:143], v4, s[12:15], s29 offen offset:1024 sc1
    buffer_load_dwordx4 v[144:147], v4, s[12:15], s29 offen offset:2048 sc1
    s_waitcnt vmcnt(12)
    s_barrier
    buffer_load_dwordx4 v[148:151], v4, s[12:15], s29 offen offset:3072 sc1
    s_add_u32 s29, s29, 4096
    buffer_load_dwordx4 v[152:155], v4, s[12:15], s29 offen offset:0 sc1
    buffer_load_dwordx4 v[156:159], v4, s[12:15], s29 offen offset:1024 sc1
    buffer_load_dwordx4 v[160:163], v4, s[12:15], s29 offen offset:2048 sc1
    buffer_load_dwordx4 v[164:167], v4, s[12:15], s29 offen offset:3072 sc1
    s_add_u32 s29, s29, 4096
    buffer_load_dwordx4 v[168:171], v4, s[12:15], s29 offen offset:0 sc1
    buffer_load_dwordx4 v[172:175], v4, s[12:15], s29 offen offset:1024 sc1
    buffer_load_dwordx4 v[176:179], v4, s[12:15], s29 offen offset:2048 sc1
    s_add_u32 s29, s29, 49152
    buffer_load_dwordx4 v[180:183], v4, s[12:15], s29 offen offset:0 sc1
    buffer_load_dwordx4 v[184:187], v4, s[12:15], s29 offen offset:1024 sc1
    buffer_load_dwordx4 v[188:191], v4, s[12:15], s29 offen offset:2048 sc1
    buffer_load_dwordx4 v[192:195], v4, s[12:15], s29 offen offset:3072 sc1
    s_add_u32 s29, s29, 4096
    s_add_u32 m0, s42, 0
    s_add_u32 s25, s35, m0
    buffer_load_dwordx4 v4, s[12:15], s25 offen sc1 lds
    s_add_u32 m0, s42, 4096
    s_add_u32 s25, s35, m0
    buffer_load_dwordx4 v4, s[12:15], s25 offen sc1 lds
    s_add_u32 m0, s42, 8192
    s_add_u32 s25, s35, m0
    buffer_load_dwordx4 v4, s[12:15], s25 offen sc1 lds
    s_add_u32 m0, s42, 12288
    s_add_u32 s25, s35, m0
    buffer_load_dwordx4 v4, s[12:15], s25 offen sc1 lds
    s_add_u32 m0, s41, 0
    s_add_u32 s25, s40, 0
    buffer_load_dwordx4 v242, s[12:15], s25 offen sc1 lds
    s_add_u32 m0, s41, 4096
    s_add_u32 s25, s40, 131072
    buffer_load_dwordx4 v242, s[12:15], s25 offen sc1 lds
    s_cmp_lt_u32 s4, 2
    s_cbranch_scc0 K2_LRP
    s_add_u32 m0, s42, 16384
    s_add_u32 s25, s35, m0
    buffer_load_dwordx4 v4, s[12:15], s25 offen sc1 lds
    s_branch K2_LSP
K2_LRP:
    s_add_u32 m0, s41, 6144
    s_add_u32 s25, s40, 196608
    buffer_load_dwordx4 v242, s[12:15], s25 offen sc1 lds
K2_LSP:
    s_waitcnt vmcnt(63)
    s_barrier
    ds_write_b128 v244, v[16:19] offset:0
    s_mov_b32 m0, s24
    s_add_u32 s25, s35, s24
    buffer_load_dwordx4 v4, s[12:15], s25 offen sc1 lds
    ds_write_b128 v244, v[20:23] offset:4096
    buffer_load_dwordx4 v4, s[12:15], s25 offen offset:1024 sc1 lds
    ds_write_b128 v244, v[24:27] offset:8192
    buffer_load_dwordx4 v4, s[12:15], s25 offen offset:2048 sc1 lds
    ds_write_b128 v244, v[28:31] offset:12288
    buffer_load_dwordx4 v4, s[12:15], s25 offen offset:3072 sc1 lds
    ds_write_b128 v244, v[32:35] offset:16384
    s_add_u32 m0, s24, 4096
    s_add_u32 s25, s25, 4096
    buffer_load_dwordx4 v4, s[12:15], s25 offen sc1 lds
    ds_write_b128 v244, v[36:39] offset:20480
    buffer_load_dwordx4 v4, s[12:15], s25 offen offset:1024 sc1 lds
    ds_write_b128 v244, v[40:43] offset:24576
    buffer_load_dwordx4 v4, s[12:15], s25 offen offset:2048 sc1 lds
    ds_write_b128 v244, v[44:47] offset:28672
    buffer_load_dwordx4 v[196:199], v4, s[12:15], s29 offen offset:0 sc1
    ds_write_b128 v244, v[48:51] offset:32768
    buffer_load_dwordx4 v[200:203], v4, s[12:15], s29 offen offset:1024 sc1
    ds_write_b128 v244, v[52:55] offset:36864
    buffer_load_dwordx4 v[204:207], v4, s[12:15], s29 offen offset:2048 sc1
    ds_write_b128 v244, v[56:59] offset:40960
    buffer_load_dwordx4 v[208:211], v4, s[12:15], s29 offen offset:3072 sc1
    s_add_u32 s29, s29, 4096
    ds_write_b128 v244, v[60:63] offset:45056
    buffer_load_dwordx4 v[212:215], v4, s[12:15], s29 offen offset:0 sc1
    ds_write_b128 v244, v[64:67] offset:49152
    buffer_load_dwordx4 v[216:219], v4, s[12:15], s29 offen offset:1024 sc1
    s_waitcnt vmcnt(39)
    ds_write_b128 v244, v[68:71] offset:53248
    buffer_load_dwordx4 v[220:223], v4, s[12:15], s29 offen offset:2048 sc1
    ds_write_b128 v244, v[72:75] offset:57344
    buffer_load_dwordx4 v[224:227], v4, s[12:15], s29 offen offset:3072 sc1
    s_add_u32 s29, s29, 4096
    ds_write_b128 v244, v[76:79] offset:61440
    buffer_load_dwordx4 v[228:231], v4, s[12:15], s29 offen offset:0 sc1
    ds_write_b128 v245, v[80:83] offset:0
    buffer_load_dwordx4 v[232:235], v4, s[12:15], s29 offen offset:1024 sc1
    ds_write_b128 v245, v[84:87] offset:4096
    buffer_load_dwordx4 v[236:239], v4, s[12:15], s29 offen offset:2048 sc1
    ds_write_b128 v245, v[88:91] offset:8192
    ds_write_b128 v245, v[92:95] offset:12288
    buffer_load_dword v11, v241, s[12:15], s38 offen sc1
    ds_write_b128 v245, v[96:99] offset:16384
    ds_write_b128 v245, v[100:103] offset:20480
    ds_write_b128 v245, v[104:107] offset:24576
    ds_write_b128 v245, v[108:111] offset:28672
    ds_write_b128 v245, v[112:115] offset:32768
    ds_write_b128 v245, v[116:119] offset:36864
    s_waitcnt vmcnt(0) lgkmcnt(0)
    v_cmp_ne_u32 vcc, s54, v11
    s_cbranch_vccz K2_PAP_OK
    s_mov_b32 s52, 0
K2_PAP:
    buffer_load_dword v11, v241, s[12:15], s38 offen sc1
    s_add_u32 s52, s52, 1
    s_waitcnt vmcnt(0)
    v_cmp_ne_u32 vcc, s54, v11
    s_cmp_lt_u32 s52, 0x40000
    s_cbranch_vccz K2_PAP_D
    s_mov_b64 exec, vcc
    s_sleep 4
    s_cbranch_scc1 K2_PAP
K2_PAP_D:
    s_mov_b64 exec, -1
K2_PAP_OK:
    s_barrier
    s_waitcnt vmcnt(0) lgkmcnt(0)
    s_barrier
    buffer_load_dword v11, v241, s[12:15], s39 offen sc1
    ds_write_b128 v240, v[120:123] offset:0
    ds_write_b128 v240, v[124:127] offset:1024
    ds_write_b128 v240, v[128:131] offset:2048
    ds_write_b128 v240, v[132:135] offset:3072
    s_waitcnt vmcnt(0)
    v_cmp_ne_u32 vcc, s54, v11
    s_cbranch_vccz K2_PBP_OK
    s_mov_b32 s52, 0
K2_PBP:
    buffer_load_dword v11, v241, s[12:15], s39 offen sc1
    s_add_u32 s52, s52, 1
    s_waitcnt vmcnt(0)
    v_cmp_ne_u32 vcc, s54, v11
    s_cmp_lt_u32 s52, 0x40000
    s_cbranch_vccz K2_PBP_D
    s_mov_b64 exec, vcc
    s_sleep 4
    s_cbranch_scc1 K2_PBP
K2_PBP_D:
    s_mov_b64 exec, -1
K2_PBP_OK:
    s_barrier
    ds_write_b128 v240, v[136:139] offset:4096
    ds_write_b128 v240, v[140:143] offset:5120
    ds_write_b128 v240, v[144:147] offset:6144
    ds_write_b128 v240, v[148:151] offset:7168
    ds_write_b128 v240, v[152:155] offset:8192
    ds_write_b128 v240, v[156:159] offset:9216
    ds_write_b128 v240, v[160:163] offset:10240
    ds_write_b128 v240, v[164:167] offset:11264
    ds_write_b128 v240, v[168:171] offset:12288
    ds_write_b128 v240, v[172:175] offset:13312
    ds_write_b128 v240, v[176:179] offset:14336
    s_waitcnt lgkmcnt(0)
    s_barrier
    s_waitcnt vmcnt(0)
    ds_write_b128 v243, v[180:183] offset:0
    ds_write_b128 v243, v[184:187] offset:1024
    ds_write_b128 v243, v[188:191] offset:2048
    ds_write_b128 v243, v[192:195] offset:3072
    ds_write_b128 v243, v[196:199] offset:4096
    ds_write_b128 v243, v[200:203] offset:5120
    ds_write_b128 v243, v[204:207] offset:6144
    ds_write_b128 v243, v[208:211] offset:7168
    ds_write_b128 v243, v[212:215] offset:8192
    ds_write_b128 v243, v[216:219] offset:9216
    ds_write_b128 v243, v[220:223] offset:10240
    ds_write_b128 v243, v[224:227] offset:11264
    ds_write_b128 v243, v[228:231] offset:12288
    ds_write_b128 v243, v[232:235] offset:13312
    ds_write_b128 v243, v[236:239] offset:14336
    s_waitcnt lgkmcnt(0)
    s_barrier
    s_or_b32 s3, s2, s4
    s_cmp_lg_u32 s3, 0
    s_cbranch_scc1 K2_LEND
    v_lshlrev_b32 v5, 7, v1
    v_add_u32 v5, 0x1865000, v5
    s_mov_b32 s52, 0
K2_PE0:
    buffer_load_dword v6, v5, s[12:15], 0 offen sc1
    s_add_u32 s52, s52, 1
    s_waitcnt vmcnt(0)
    v_cmp_ne_u32 vcc, s54, v6
    s_cmp_lt_u32 s52, 0x40000
    s_cbranch_vccz K2_PE0_D
    s_mov_b64 exec, vcc
    s_sleep 2
    s_cbranch_scc1 K2_PE0
K2_PE0_D:
    s_mov_b64 exec, -1
    v_add_u32 v5, 4096, v5
    s_mov_b32 s52, 0
K2_PE1:
    buffer_load_dword v6, v5, s[12:15], 0 offen sc1
    s_add_u32 s52, s52, 1
    s_waitcnt vmcnt(0)
    v_cmp_ne_u32 vcc, s54, v6
    s_cmp_lt_u32 s52, 0x40000
    s_cbranch_vccz K2_PE1_D
    s_mov_b64 exec, vcc
    s_sleep 2
    s_cbranch_scc1 K2_PE1
K2_PE1_D:
    s_mov_b64 exec, -1
    v_mov_b32 v6, 0
    v_mov_b32 v7, s54
    s_mov_b64 exec, 1
    global_store_dword v6, v7, s[6:7] sc1
    s_mov_b64 exec, -1
K2_LEND:
    s_endpgm
K2_COMPP:
    s_waitcnt lgkmcnt(0)
    s_add_u32 s54, s54, 0x9e3779b9
K2_COMP:
    v_mov_b32 v13, s54
    s_and_b32 s3, s2, 7
    s_lshr_b32 s5, s2, 3
    s_cmp_lt_u32 s5, 20
    s_cselect_b32 s16, 0, 20
    s_cselect_b32 s17, 5, 3
    s_cselect_b32 s18, 52, 86
    s_cselect_b32 s19, 0, 10
    s_sub_u32 s5, s5, s16
    s_mul_i32 s18, s5, s18
    s_lshr_b32 s18, s18, 8
    s_mul_i32 s36, s18, s17
    s_sub_u32 s5, s5, s36
    s_lshr_b32 s38, s3, 1
    s_and_b32 s3, s3, 1
    s_mul_i32 s36, s38, s17
    s_add_u32 s36, s36, s5
    s_add_u32 s36, s36, s16
    s_lshl_b32 s37, s3, 2
    s_add_u32 s37, s37, s18
    s_mul_i32 s16, s3, s17
    s_add_u32 s16, s16, s5
    s_add_u32 s16, s16, s19
    s_lshl_b32 s17, s38, 2
    s_add_u32 s17, s17, s18
    s_lshr_b32 s18, s4, 1
    s_and_b32 s19, s4, 1
    v_lshlrev_b32 v4, 4, v1
    v_lshrrev_b32 v5, 2, v1
    v_and_b32 v6, 7, v5
    v_and_b32 v7, 3, v1
    v_lshlrev_b32 v5, 8, v5
    v_lshl_add_u32 v5, v7, 3, v5
    v_add_u32 v5, 16384, v5
    s_lshl_b32 s25, s18, 2
    s_add_u32 s26, s25, 0
    v_xor_b32 v7, s26, v6
    v_lshl_add_u32 v8, v7, 5, v5
    s_add_u32 s26, s25, 1
    v_xor_b32 v7, s26, v6
    v_lshl_add_u32 v9, v7, 5, v5
    s_add_u32 s26, s25, 2
    v_xor_b32 v7, s26, v6
    v_lshl_add_u32 v10, v7, 5, v5
    s_add_u32 s26, s25, 3
    v_xor_b32 v7, s26, v6
    v_lshl_add_u32 v11, v7, 5, v5
    s_mul_i32 s25, s19, 7168
    s_add_u32 s25, s25, 77824
    v_add_u32 v12, s25, v4
    s_mov_b32 s8, s94
    s_mov_b32 s9, s95
    s_mov_b32 s10, 0x280000
    s_mov_b32 s11, 0x00020000
    v_mov_b32 v216, 0x3f803f80
    v_mov_b32 v217, 0x3f803f80
    v_mov_b32 v218, 0x3f803f80
    v_mov_b32 v219, 0x3f803f80
    s_mov_b32 s33, 16384
    s_mov_b32 s34, 28672
    s_mov_b32 s27, 0
    s_mov_b32 s28, 1
    s_waitcnt vmcnt(0)
    s_barrier
    v_mov_b64 v[16:17], 0
    v_mov_b64 v[18:19], 0
    v_mov_b64 v[20:21], 0
    v_mov_b64 v[22:23], 0
    v_mov_b64 v[24:25], 0
    v_mov_b64 v[26:27], 0
    v_mov_b64 v[28:29], 0
    v_mov_b64 v[30:31], 0
    v_mov_b64 v[32:33], 0
    v_mov_b64 v[34:35], 0
    v_mov_b64 v[36:37], 0
    v_mov_b64 v[38:39], 0
    v_mov_b64 v[40:41], 0
    v_mov_b64 v[42:43], 0
    v_mov_b64 v[44:45], 0
    v_mov_b64 v[46:47], 0
    v_mov_b64 v[48:49], 0
    v_mov_b64 v[50:51], 0
    v_mov_b64 v[52:53], 0
    v_mov_b64 v[54:55], 0
    v_mov_b64 v[56:57], 0
    v_mov_b64 v[58:59], 0
    v_mov_b64 v[60:61], 0
    v_mov_b64 v[62:63], 0
    v_mov_b64 v[64:65], 0
    v_mov_b64 v[66:67], 0
    v_mov_b64 v[68:69], 0
    v_mov_b64 v[70:71], 0
    v_mov_b64 v[72:73], 0
    v_mov_b64 v[74:75], 0
    v_mov_b64 v[76:77], 0
    v_mov_b64 v[78:79], 0
    v_mov_b64 v[80:81], 0
    v_mov_b64 v[82:83], 0
    v_mov_b64 v[84:85], 0
    v_mov_b64 v[86:87], 0
    v_mov_b64 v[88:89], 0
    v_mov_b64 v[90:91], 0
    v_mov_b64 v[92:93], 0
    v_mov_b64 v[94:95], 0
    v_mov_b64 v[96:97], 0
    v_mov_b64 v[98:99], 0
    v_mov_b64 v[100:101], 0
    v_mov_b64 v[102:103], 0
    v_mov_b64 v[104:105], 0
    v_mov_b64 v[106:107], 0
    v_mov_b64 v[108:109], 0
    v_mov_b64 v[110:111], 0
    v_mov_b64 v[112:113], 0
    v_mov_b64 v[114:115], 0
    v_mov_b64 v[116:117], 0
    v_mov_b64 v[118:119], 0
    v_mov_b64 v[120:121], 0
    v_mov_b64 v[122:123], 0
    v_mov_b64 v[124:125], 0
    v_mov_b64 v[126:127], 0
    s_lshr_b32 s20, s17, 1
    s_mul_i32 s20, s20, 3
    s_and_b32 s21, s17, 1
    s_lshl_b32 s23, s16, 3
    s_lshl_b32 s24, s18, 2
    s_add_u32 s23, s23, s24
    s_mul_i32 s23, s23, 55296
    s_add_u32 s23, s23, 0x910000
    s_lshl_b32 s24, s17, 1
    s_add_u32 s24, s24, s19
    s_add_u32 s24, s24, 23
    s_lshl_b32 s24, s24, 10
    s_add_u32 s40, s24, s23
    s_lshl_b32 s25, s21, 1
    s_add_u32 s25, s25, s20
    s_lshl_b32 s25, s25, 10
    s_lshl_b32 s26, s19, 9
    s_add_u32 s25, s25, s26
    s_add_u32 s26, s20, 1
    s_lshl_b32 s26, s26, 10
    s_lshl_b32 s29, s21, 9
    s_add_u32 s26, s26, s29
    s_cmp_eq_u32 s17, 15
    s_cselect_b32 s25, s26, s25
    s_add_u32 s41, s25, s23
    s_add_u32 s26, s26, s23
    s_lshl_b32 s29, s19, 8
    s_add_u32 s42, s26, s29
    s_cmp_eq_u32 s17, 15
    s_cselect_b32 s42, 0x40000000, s42
    v_and_b32 v5, 31, v1
    v_lshlrev_b32 v5, 4, v5
    v_lshrrev_b32 v6, 5, v1
    v_mul_u32_u24 v6, 55296, v6
    v_add_u32 v220, v5, v6
    v_and_b32 v7, 15, v1
    v_lshl_add_u32 v7, v7, 4, v6
    v_bfe_u32 v5, v1, 4, 1
    v_mul_u32_u24 v5, 110592, v5
    v_add_u32 v221, v7, v5
    v_and_b32 v2, 15, v1
    v_lshlrev_b32 v14, 2, v2
    s_lshl_b32 s20, s16, 1
    s_add_u32 s20, s20, s18
    s_lshl_b32 s20, s20, 5
    s_lshl_b32 s21, s17, 1
    s_add_u32 s20, s20, s21
    s_add_u32 s20, s20, s19
    s_lshl_b32 s20, s20, 6
    s_add_u32 s43, s20, 0x1840000
    s_add_u32 s44, s20, 0x1850000
    s_lshl_b32 s22, s36, 2
    s_add_u32 s22, s22, s4
    s_mul_i32 s23, s22, 55296
    s_xor_b32 s24, s22, 1
    s_mul_i32 s24, s24, 55296
    v_add_u32 v222, s23, v4
    v_add_u32 v223, s24, v4
    s_lshl_b32 s45, s19, 10
    s_add_u32 s45, s45, 0x910000
    s_mul_i32 s24, s19, 5120
    v_add_u32 v224, s24, v4
    v_add_u32 v225, 61440, v224
    v_add_u32 v226, 122880, v224
    v_and_b32 v2, 15, v1
    v_lshrrev_b32 v3, 4, v1
    v_lshrrev_b32 v5, 2, v1
    v_lshlrev_b32 v5, 7, v5
    v_and_b32 v6, 3, v1
    v_lshl_add_u32 v5, v6, 3, v5
    s_lshl_b32 s24, s4, 5
    s_add_u32 s24, s24, 153600
    v_add_u32 v227, s24, v5
    v_lshlrev_b32 v228, 2, v2
    s_lshl_b32 s22, s22, 4
    s_lshl_b32 s46, s22, 2
    s_add_u32 s46, s46, 0x8000
    s_mul_i32 s47, s22, 1280
    s_mul_i32 s24, s37, 160
    s_add_u32 s47, s47, s24
    v_mul_u32_u24 v5, 1280, v2
    v_lshl_add_u32 v229, v3, 3, v5
    v_lshrrev_b32 v2, 1, v3
    v_lshl_add_u32 v5, v2, 4, v5
    v_and_b32 v2, 1, v3
    v_lshl_add_u32 v230, v2, 5, v5
    s_mul_i32 s24, s4, 5120
    s_add_u32 s24, s24, 122880
    v_add_u32 v231, s24, v4
    s_xor_b32 s24, s4, 1
    s_mul_i32 s24, s24, 5120
    s_add_u32 s24, s24, 122880
    v_add_u32 v232, s24, v4
    s_barrier
    ds_read_b128 v[144:147], v12 offset:0
    ds_read_b64_tr_b16 v[128:129], v8 offset:0
    ds_read_b64_tr_b16 v[130:131], v8 offset:4096
    ds_read_b64_tr_b16 v[132:133], v9 offset:0
    ds_read_b64_tr_b16 v[134:135], v9 offset:4096
    ds_read_b64_tr_b16 v[136:137], v10 offset:0
    ds_read_b64_tr_b16 v[138:139], v10 offset:4096
    ds_read_b64_tr_b16 v[140:141], v11 offset:0
    ds_read_b64_tr_b16 v[142:143], v11 offset:4096
    ds_read_b128 v[148:151], v12 offset:1024
    ds_read_b128 v[152:155], v12 offset:2048
    ds_read_b128 v[156:159], v12 offset:3072
    ds_read_b128 v[160:163], v12 offset:4096
    ds_read_b128 v[164:167], v12 offset:5120
    ds_read_b128 v[168:171], v12 offset:6144
    s_cmp_eq_u32 s17, 15
    s_cselect_b32 s29, s19, 0
    s_cmp_eq_u32 s29, 1
    s_cbranch_scc1 K2_STAT
    .p2align 3
K2_LOOP:
    s_waitcnt lgkmcnt(0)
    s_add_u32 s27, s27, 1
    v_mfma_f32_16x16x32_bf16 v[16:19], v[144:147], v[128:131], v[16:19]
    ds_read_b128 v[188:191], v12 offset:14336
    v_mfma_f32_16x16x32_bf16 v[20:23], v[144:147], v[132:135], v[20:23]
    ds_read_b64_tr_b16 v[172:173], v8 offset:8192
    v_mfma_f32_16x16x32_bf16 v[24:27], v[144:147], v[136:139], v[24:27]
    ds_read_b64_tr_b16 v[174:175], v8 offset:12288
    v_mfma_f32_16x16x32_bf16 v[28:31], v[144:147], v[140:143], v[28:31]
    ds_read_b64_tr_b16 v[176:177], v9 offset:8192
    v_mfma_f32_16x16x32_bf16 v[32:35], v[148:151], v[128:131], v[32:35]
    ds_read_b64_tr_b16 v[178:179], v9 offset:12288
    v_mfma_f32_16x16x32_bf16 v[36:39], v[148:151], v[132:135], v[36:39]
    ds_read_b64_tr_b16 v[180:181], v10 offset:8192
    v_mfma_f32_16x16x32_bf16 v[40:43], v[148:151], v[136:139], v[40:43]
    ds_read_b64_tr_b16 v[182:183], v10 offset:12288
    v_mfma_f32_16x16x32_bf16 v[44:47], v[148:151], v[140:143], v[44:47]
    ds_read_b64_tr_b16 v[184:185], v11 offset:8192
    v_mfma_f32_16x16x32_bf16 v[48:51], v[152:155], v[128:131], v[48:51]
    ds_read_b64_tr_b16 v[186:187], v11 offset:12288
    v_mfma_f32_16x16x32_bf16 v[52:55], v[152:155], v[132:135], v[52:55]
    ds_read_b128 v[192:195], v12 offset:15360
    v_mfma_f32_16x16x32_bf16 v[56:59], v[152:155], v[136:139], v[56:59]
    ds_read_b128 v[196:199], v12 offset:16384
    v_mfma_f32_16x16x32_bf16 v[60:63], v[152:155], v[140:143], v[60:63]
    ds_read_b128 v[200:203], v12 offset:17408
    v_mfma_f32_16x16x32_bf16 v[64:67], v[156:159], v[128:131], v[64:67]
    ds_read_b128 v[204:207], v12 offset:18432
    v_mfma_f32_16x16x32_bf16 v[68:71], v[156:159], v[132:135], v[68:71]
    ds_read_b128 v[208:211], v12 offset:19456
    v_mfma_f32_16x16x32_bf16 v[72:75], v[156:159], v[136:139], v[72:75]
    ds_read_b128 v[212:215], v12 offset:20480
    v_mfma_f32_16x16x32_bf16 v[76:79], v[156:159], v[140:143], v[76:79]
    s_add_u32 s28, s28, 1
    s_cmp_eq_u32 s28, 3
    v_mfma_f32_16x16x32_bf16 v[80:83], v[160:163], v[128:131], v[80:83]
    s_cselect_b32 s30, 0xffff8000, s33
    v_mfma_f32_16x16x32_bf16 v[84:87], v[160:163], v[132:135], v[84:87]
    s_cselect_b32 s31, 0xffff2000, s34
    v_mfma_f32_16x16x32_bf16 v[88:91], v[160:163], v[136:139], v[88:91]
    s_cselect_b32 s28, 0, s28
    v_add_u32 v8, s30, v8
    v_mfma_f32_16x16x32_bf16 v[92:95], v[160:163], v[140:143], v[92:95]
    v_add_u32 v9, s30, v9
    v_add_u32 v10, s30, v10
    v_mfma_f32_16x16x32_bf16 v[96:99], v[164:167], v[128:131], v[96:99]
    v_add_u32 v11, s30, v11
    v_add_u32 v12, s31, v12
    v_mfma_f32_16x16x32_bf16 v[100:103], v[164:167], v[132:135], v[100:103]
    v_mfma_f32_16x16x32_bf16 v[104:107], v[164:167], v[136:139], v[104:107]
    v_mfma_f32_16x16x32_bf16 v[108:111], v[164:167], v[140:143], v[108:111]
    v_mfma_f32_16x16x32_bf16 v[112:115], v[168:171], v[128:131], v[112:115]
    v_mfma_f32_16x16x32_bf16 v[116:119], v[168:171], v[132:135], v[116:119]
    v_mfma_f32_16x16x32_bf16 v[120:123], v[168:171], v[136:139], v[120:123]
    v_mfma_f32_16x16x32_bf16 v[124:127], v[168:171], v[140:143], v[124:127]
    s_waitcnt lgkmcnt(0)
    s_barrier
    v_mfma_f32_16x16x32_bf16 v[16:19], v[188:191], v[172:175], v[16:19]
    ds_read_b128 v[144:147], v12 offset:0
    v_mfma_f32_16x16x32_bf16 v[20:23], v[188:191], v[176:179], v[20:23]
    ds_read_b64_tr_b16 v[128:129], v8 offset:0
    v_mfma_f32_16x16x32_bf16 v[24:27], v[188:191], v[180:183], v[24:27]
    ds_read_b64_tr_b16 v[130:131], v8 offset:4096
    v_mfma_f32_16x16x32_bf16 v[28:31], v[188:191], v[184:187], v[28:31]
    ds_read_b64_tr_b16 v[132:133], v9 offset:0
    v_mfma_f32_16x16x32_bf16 v[32:35], v[192:195], v[172:175], v[32:35]
    ds_read_b64_tr_b16 v[134:135], v9 offset:4096
    v_mfma_f32_16x16x32_bf16 v[36:39], v[192:195], v[176:179], v[36:39]
    ds_read_b64_tr_b16 v[136:137], v10 offset:0
    v_mfma_f32_16x16x32_bf16 v[40:43], v[192:195], v[180:183], v[40:43]
    ds_read_b64_tr_b16 v[138:139], v10 offset:4096
    v_mfma_f32_16x16x32_bf16 v[44:47], v[192:195], v[184:187], v[44:47]
    ds_read_b64_tr_b16 v[140:141], v11 offset:0
    v_mfma_f32_16x16x32_bf16 v[48:51], v[196:199], v[172:175], v[48:51]
    ds_read_b64_tr_b16 v[142:143], v11 offset:4096
    v_mfma_f32_16x16x32_bf16 v[52:55], v[196:199], v[176:179], v[52:55]
    ds_read_b128 v[148:151], v12 offset:1024
    v_mfma_f32_16x16x32_bf16 v[56:59], v[196:199], v[180:183], v[56:59]
    ds_read_b128 v[152:155], v12 offset:2048
    v_mfma_f32_16x16x32_bf16 v[60:63], v[196:199], v[184:187], v[60:63]
    ds_read_b128 v[156:159], v12 offset:3072
    v_mfma_f32_16x16x32_bf16 v[64:67], v[200:203], v[172:175], v[64:67]
    ds_read_b128 v[160:163], v12 offset:4096
    v_mfma_f32_16x16x32_bf16 v[68:71], v[200:203], v[176:179], v[68:71]
    ds_read_b128 v[164:167], v12 offset:5120
    v_mfma_f32_16x16x32_bf16 v[72:75], v[200:203], v[180:183], v[72:75]
    ds_read_b128 v[168:171], v12 offset:6144
    v_mfma_f32_16x16x32_bf16 v[76:79], v[200:203], v[184:187], v[76:79]
    v_mfma_f32_16x16x32_bf16 v[80:83], v[204:207], v[172:175], v[80:83]
    v_mfma_f32_16x16x32_bf16 v[84:87], v[204:207], v[176:179], v[84:87]
    v_mfma_f32_16x16x32_bf16 v[88:91], v[204:207], v[180:183], v[88:91]
    v_mfma_f32_16x16x32_bf16 v[92:95], v[204:207], v[184:187], v[92:95]
    v_mfma_f32_16x16x32_bf16 v[96:99], v[208:211], v[172:175], v[96:99]
    v_mfma_f32_16x16x32_bf16 v[100:103], v[208:211], v[176:179], v[100:103]
    v_mfma_f32_16x16x32_bf16 v[104:107], v[208:211], v[180:183], v[104:107]
    v_mfma_f32_16x16x32_bf16 v[108:111], v[208:211], v[184:187], v[108:111]
    v_mfma_f32_16x16x32_bf16 v[112:115], v[212:215], v[172:175], v[112:115]
    v_mfma_f32_16x16x32_bf16 v[116:119], v[212:215], v[176:179], v[116:119]
    v_mfma_f32_16x16x32_bf16 v[120:123], v[212:215], v[180:183], v[120:123]
    v_mfma_f32_16x16x32_bf16 v[124:127], v[212:215], v[184:187], v[124:127]
    s_cmp_lt_u32 s27, 7
    s_cbranch_scc1 K2_LOOP
    v_subrev_u32 v8, 32768, v8
    v_subrev_u32 v9, 32768, v9
    v_subrev_u32 v10, 32768, v10
    v_subrev_u32 v11, 32768, v11
    v_subrev_u32 v15, 57344, v12
    s_waitcnt lgkmcnt(0)
    v_mfma_f32_16x16x32_bf16 v[48:51], v[152:155], v[128:131], v[48:51]
    ds_read_b128 v[188:191], v12 offset:16384
    ds_read_b64_tr_b16 v[172:173], v8 offset:40960
    v_mfma_f32_16x16x32_bf16 v[52:55], v[152:155], v[132:135], v[52:55]
    ds_read_b64_tr_b16 v[174:175], v8 offset:45056
    ds_read_b64_tr_b16 v[176:177], v9 offset:40960
    v_mfma_f32_16x16x32_bf16 v[56:59], v[152:155], v[136:139], v[56:59]
    ds_read_b64_tr_b16 v[178:179], v9 offset:45056
    ds_read_b64_tr_b16 v[180:181], v10 offset:40960
    v_mfma_f32_16x16x32_bf16 v[60:63], v[152:155], v[140:143], v[60:63]
    ds_read_b64_tr_b16 v[182:183], v10 offset:45056
    ds_read_b64_tr_b16 v[184:185], v11 offset:40960
    v_mfma_f32_16x16x32_bf16 v[96:99], v[164:167], v[128:131], v[96:99]
    ds_read_b64_tr_b16 v[186:187], v11 offset:45056
    ds_read_b128 v[192:195], v12 offset:19456
    v_mfma_f32_16x16x32_bf16 v[100:103], v[164:167], v[132:135], v[100:103]
    ds_read_b128 v[196:199], v12 offset:20480
    v_mfma_f32_16x16x32_bf16 v[104:107], v[164:167], v[136:139], v[104:107]
    s_barrier
    ds_read_b128 v[248:251], v15 offset:2048
    ds_read_b64_tr_b16 v[204:205], v8 offset:0
    v_mfma_f32_16x16x32_bf16 v[108:111], v[164:167], v[140:143], v[108:111]
    ds_read_b64_tr_b16 v[206:207], v8 offset:4096
    ds_read_b64_tr_b16 v[208:209], v9 offset:0
    v_mfma_f32_16x16x32_bf16 v[112:115], v[168:171], v[128:131], v[112:115]
    ds_read_b64_tr_b16 v[210:211], v9 offset:4096
    ds_read_b64_tr_b16 v[212:213], v10 offset:0
    v_mfma_f32_16x16x32_bf16 v[116:119], v[168:171], v[132:135], v[116:119]
    ds_read_b64_tr_b16 v[214:215], v10 offset:4096
    ds_read_b64_tr_b16 v[216:217], v11 offset:0
    v_mfma_f32_16x16x32_bf16 v[120:123], v[168:171], v[136:139], v[120:123]
    ds_read_b64_tr_b16 v[218:219], v11 offset:4096
    ds_read_b128 v[148:151], v15 offset:5120
    v_mfma_f32_16x16x32_bf16 v[124:127], v[168:171], v[140:143], v[124:127]
    ds_read_b128 v[156:159], v15 offset:6144
    s_waitcnt lgkmcnt(11)
    v_mfma_f32_16x16x32_bf16 v[48:51], v[188:191], v[172:175], v[48:51]
    ds_read_b128 v[152:155], v15 offset:16384
    v_mfma_f32_16x16x32_bf16 v[52:55], v[188:191], v[176:179], v[52:55]
    ds_read_b64_tr_b16 v[128:129], v8 offset:8192
    v_mfma_f32_16x16x32_bf16 v[56:59], v[188:191], v[180:183], v[56:59]
    ds_read_b64_tr_b16 v[130:131], v8 offset:12288
    v_mfma_f32_16x16x32_bf16 v[60:63], v[188:191], v[184:187], v[60:63]
    ds_read_b64_tr_b16 v[132:133], v9 offset:8192
    v_mfma_f32_16x16x32_bf16 v[96:99], v[192:195], v[172:175], v[96:99]
    ds_read_b64_tr_b16 v[134:135], v9 offset:12288
    v_mfma_f32_16x16x32_bf16 v[100:103], v[192:195], v[176:179], v[100:103]
    ds_read_b64_tr_b16 v[136:137], v10 offset:8192
    v_mfma_f32_16x16x32_bf16 v[104:107], v[192:195], v[180:183], v[104:107]
    ds_read_b64_tr_b16 v[138:139], v10 offset:12288
    v_mfma_f32_16x16x32_bf16 v[108:111], v[192:195], v[184:187], v[108:111]
    ds_read_b64_tr_b16 v[140:141], v11 offset:8192
    v_mfma_f32_16x16x32_bf16 v[112:115], v[196:199], v[172:175], v[112:115]
    ds_read_b64_tr_b16 v[142:143], v11 offset:12288
    v_mfma_f32_16x16x32_bf16 v[116:119], v[196:199], v[176:179], v[116:119]
    ds_read_b128 v[164:167], v15 offset:19456
    v_mfma_f32_16x16x32_bf16 v[120:123], v[196:199], v[180:183], v[120:123]
    ds_read_b128 v[168:171], v15 offset:20480
    v_mfma_f32_16x16x32_bf16 v[124:127], v[196:199], v[184:187], v[124:127]
    s_waitcnt lgkmcnt(11)
    s_barrier
    v_mfma_f32_16x16x32_bf16 v[48:51], v[248:251], v[204:207], v[48:51]
    ds_read_b128 v[188:191], v15 offset:30720
    v_mfma_f32_16x16x32_bf16 v[52:55], v[248:251], v[208:211], v[52:55]
    ds_read_b64_tr_b16 v[172:173], v8 offset:16384
    v_mfma_f32_16x16x32_bf16 v[56:59], v[248:251], v[212:215], v[56:59]
    ds_read_b64_tr_b16 v[174:175], v8 offset:20480
    v_mfma_f32_16x16x32_bf16 v[60:63], v[248:251], v[216:219], v[60:63]
    ds_read_b64_tr_b16 v[176:177], v9 offset:16384
    v_mfma_f32_16x16x32_bf16 v[96:99], v[148:151], v[204:207], v[96:99]
    ds_read_b64_tr_b16 v[178:179], v9 offset:20480
    v_mfma_f32_16x16x32_bf16 v[100:103], v[148:151], v[208:211], v[100:103]
    ds_read_b64_tr_b16 v[180:181], v10 offset:16384
    v_mfma_f32_16x16x32_bf16 v[104:107], v[148:151], v[212:215], v[104:107]
    ds_read_b64_tr_b16 v[182:183], v10 offset:20480
    v_mfma_f32_16x16x32_bf16 v[108:111], v[148:151], v[216:219], v[108:111]
    ds_read_b64_tr_b16 v[184:185], v11 offset:16384
    v_mfma_f32_16x16x32_bf16 v[112:115], v[156:159], v[204:207], v[112:115]
    ds_read_b64_tr_b16 v[186:187], v11 offset:20480
    v_mfma_f32_16x16x32_bf16 v[116:119], v[156:159], v[208:211], v[116:119]
    ds_read_b128 v[192:195], v15 offset:33792
    v_mfma_f32_16x16x32_bf16 v[120:123], v[156:159], v[212:215], v[120:123]
    ds_read_b128 v[196:199], v15 offset:34816
    v_mfma_f32_16x16x32_bf16 v[124:127], v[156:159], v[216:219], v[124:127]
    s_waitcnt lgkmcnt(11)
    v_mfma_f32_16x16x32_bf16 v[48:51], v[152:155], v[128:131], v[48:51]
    ds_read_b128 v[248:251], v15 offset:45056
    v_mfma_f32_16x16x32_bf16 v[52:55], v[152:155], v[132:135], v[52:55]
    ds_read_b64_tr_b16 v[204:205], v8 offset:24576
    v_mfma_f32_16x16x32_bf16 v[56:59], v[152:155], v[136:139], v[56:59]
    ds_read_b64_tr_b16 v[206:207], v8 offset:28672
    v_mfma_f32_16x16x32_bf16 v[60:63], v[152:155], v[140:143], v[60:63]
    ds_read_b64_tr_b16 v[208:209], v9 offset:24576
    v_mfma_f32_16x16x32_bf16 v[96:99], v[164:167], v[128:131], v[96:99]
    ds_read_b64_tr_b16 v[210:211], v9 offset:28672
    v_mfma_f32_16x16x32_bf16 v[100:103], v[164:167], v[132:135], v[100:103]
    ds_read_b64_tr_b16 v[212:213], v10 offset:24576
    v_mfma_f32_16x16x32_bf16 v[104:107], v[164:167], v[136:139], v[104:107]
    ds_read_b64_tr_b16 v[214:215], v10 offset:28672
    v_mfma_f32_16x16x32_bf16 v[108:111], v[164:167], v[140:143], v[108:111]
    ds_read_b64_tr_b16 v[216:217], v11 offset:24576
    v_mfma_f32_16x16x32_bf16 v[112:115], v[168:171], v[128:131], v[112:115]
    ds_read_b64_tr_b16 v[218:219], v11 offset:28672
    v_mfma_f32_16x16x32_bf16 v[116:119], v[168:171], v[132:135], v[116:119]
    ds_read_b128 v[148:151], v15 offset:48128
    v_mfma_f32_16x16x32_bf16 v[120:123], v[168:171], v[136:139], v[120:123]
    ds_read_b128 v[156:159], v15 offset:49152
    v_mfma_f32_16x16x32_bf16 v[124:127], v[168:171], v[140:143], v[124:127]
    s_waitcnt lgkmcnt(11)
    v_mfma_f32_16x16x32_bf16 v[48:51], v[188:191], v[172:175], v[48:51]
    ds_read_b128 v[152:155], v12 offset:0
    v_mfma_f32_16x16x32_bf16 v[52:55], v[188:191], v[176:179], v[52:55]
    ds_read_b64_tr_b16 v[128:129], v8 offset:32768
    v_mfma_f32_16x16x32_bf16 v[56:59], v[188:191], v[180:183], v[56:59]
    ds_read_b64_tr_b16 v[130:131], v8 offset:36864
    v_mfma_f32_16x16x32_bf16 v[60:63], v[188:191], v[184:187], v[60:63]
    ds_read_b64_tr_b16 v[132:133], v9 offset:32768
    v_mfma_f32_16x16x32_bf16 v[96:99], v[192:195], v[172:175], v[96:99]
    ds_read_b64_tr_b16 v[134:135], v9 offset:36864
    v_mfma_f32_16x16x32_bf16 v[100:103], v[192:195], v[176:179], v[100:103]
    ds_read_b64_tr_b16 v[136:137], v10 offset:32768
    v_mfma_f32_16x16x32_bf16 v[104:107], v[192:195], v[180:183], v[104:107]
    ds_read_b64_tr_b16 v[138:139], v10 offset:36864
    v_mfma_f32_16x16x32_bf16 v[108:111], v[192:195], v[184:187], v[108:111]
    ds_read_b64_tr_b16 v[140:141], v11 offset:32768
    v_mfma_f32_16x16x32_bf16 v[112:115], v[196:199], v[172:175], v[112:115]
    ds_read_b64_tr_b16 v[142:143], v11 offset:36864
    v_mfma_f32_16x16x32_bf16 v[116:119], v[196:199], v[176:179], v[116:119]
    ds_read_b128 v[164:167], v12 offset:3072
    v_mfma_f32_16x16x32_bf16 v[120:123], v[196:199], v[180:183], v[120:123]
    ds_read_b128 v[168:171], v12 offset:1024
    v_mfma_f32_16x16x32_bf16 v[124:127], v[196:199], v[184:187], v[124:127]
    ds_read_b128 v[144:147], v12 offset:4096
    s_waitcnt lgkmcnt(12)
    v_mfma_f32_16x16x32_bf16 v[48:51], v[248:251], v[204:207], v[48:51]
    ds_read_b128 v[188:191], v12 offset:14336
    v_mfma_f32_16x16x32_bf16 v[52:55], v[248:251], v[208:211], v[52:55]
    ds_read_b64_tr_b16 v[172:173], v8 offset:40960
    v_mfma_f32_16x16x32_bf16 v[56:59], v[248:251], v[212:215], v[56:59]
    ds_read_b64_tr_b16 v[174:175], v8 offset:45056
    v_mfma_f32_16x16x32_bf16 v[60:63], v[248:251], v[216:219], v[60:63]
    ds_read_b64_tr_b16 v[176:177], v9 offset:40960
    v_mfma_f32_16x16x32_bf16 v[96:99], v[148:151], v[204:207], v[96:99]
    ds_read_b64_tr_b16 v[178:179], v9 offset:45056
    v_mfma_f32_16x16x32_bf16 v[100:103], v[148:151], v[208:211], v[100:103]
    ds_read_b64_tr_b16 v[180:181], v10 offset:40960
    v_mfma_f32_16x16x32_bf16 v[104:107], v[148:151], v[212:215], v[104:107]
    ds_read_b64_tr_b16 v[182:183], v10 offset:45056
    v_mfma_f32_16x16x32_bf16 v[108:111], v[148:151], v[216:219], v[108:111]
    ds_read_b64_tr_b16 v[184:185], v11 offset:40960
    v_mfma_f32_16x16x32_bf16 v[112:115], v[156:159], v[204:207], v[112:115]
    ds_read_b64_tr_b16 v[186:187], v11 offset:45056
    v_mfma_f32_16x16x32_bf16 v[116:119], v[156:159], v[208:211], v[116:119]
    ds_read_b128 v[192:195], v12 offset:17408
    v_mfma_f32_16x16x32_bf16 v[120:123], v[156:159], v[212:215], v[120:123]
    ds_read_b128 v[196:199], v12 offset:15360
    v_mfma_f32_16x16x32_bf16 v[124:127], v[156:159], v[216:219], v[124:127]
    ds_read_b128 v[200:203], v12 offset:18432
    s_waitcnt lgkmcnt(12)
    v_mfma_f32_16x16x32_bf16 v[16:19], v[152:155], v[128:131], v[16:19]
    ds_read_b128 v[248:251], v15 offset:0
    v_mfma_f32_16x16x32_bf16 v[20:23], v[152:155], v[132:135], v[20:23]
    ds_read_b64_tr_b16 v[204:205], v8 offset:0
    v_mfma_f32_16x16x32_bf16 v[24:27], v[152:155], v[136:139], v[24:27]
    ds_read_b64_tr_b16 v[206:207], v8 offset:4096
    v_mfma_f32_16x16x32_bf16 v[28:31], v[152:155], v[140:143], v[28:31]
    ds_read_b64_tr_b16 v[208:209], v9 offset:0
    v_pk_mul_f32 v[48:49], v[48:49], v[96:97]
    v_pk_mul_f32 v[50:51], v[50:51], v[98:99]
    v_mfma_f32_16x16x32_bf16 v[64:67], v[164:167], v[128:131], v[64:67]
    ds_read_b64_tr_b16 v[210:211], v9 offset:4096
    v_cvt_pk_bf16_f32 v234, v48, v49
    v_cvt_pk_bf16_f32 v235, v50, v51
    v_mfma_f32_16x16x32_bf16 v[68:71], v[164:167], v[132:135], v[68:71]
    ds_read_b64_tr_b16 v[212:213], v10 offset:0
    v_pk_mul_f32 v[52:53], v[52:53], v[100:101]
    v_pk_mul_f32 v[54:55], v[54:55], v[102:103]
    v_mfma_f32_16x16x32_bf16 v[72:75], v[164:167], v[136:139], v[72:75]
    ds_read_b64_tr_b16 v[214:215], v10 offset:4096
    v_cvt_pk_bf16_f32 v236, v52, v53
    v_cvt_pk_bf16_f32 v237, v54, v55
    v_mfma_f32_16x16x32_bf16 v[76:79], v[164:167], v[140:143], v[76:79]
    ds_read_b64_tr_b16 v[216:217], v11 offset:0
    s_nop 1
    v_permlane32_swap_b32 v234, v236
    v_mfma_f32_16x16x32_bf16 v[32:35], v[168:171], v[128:131], v[32:35]
    ds_read_b64_tr_b16 v[218:219], v11 offset:4096
    v_permlane32_swap_b32 v235, v237
    buffer_store_dwordx4 v[234:237], v220, s[12:15], s41 offen sc1
    s_add_u32 s41, s41, 110592
    v_mfma_f32_16x16x32_bf16 v[36:39], v[168:171], v[132:135], v[36:39]
    ds_read_b128 v[148:151], v15 offset:3072
    v_pk_mul_f32 v[56:57], v[56:57], v[104:105]
    v_pk_mul_f32 v[58:59], v[58:59], v[106:107]
    v_mfma_f32_16x16x32_bf16 v[40:43], v[168:171], v[136:139], v[40:43]
    ds_read_b128 v[156:159], v15 offset:1024
    v_cvt_pk_bf16_f32 v238, v56, v57
    v_cvt_pk_bf16_f32 v239, v58, v59
    v_mfma_f32_16x16x32_bf16 v[44:47], v[168:171], v[140:143], v[44:47]
    ds_read_b128 v[160:163], v15 offset:4096
    v_pk_mul_f32 v[60:61], v[60:61], v[108:109]
    v_pk_mul_f32 v[62:63], v[62:63], v[110:111]
    v_mfma_f32_16x16x32_bf16 v[80:83], v[144:147], v[128:131], v[80:83]
    v_cvt_pk_bf16_f32 v240, v60, v61
    v_cvt_pk_bf16_f32 v241, v62, v63
    v_mfma_f32_16x16x32_bf16 v[84:87], v[144:147], v[132:135], v[84:87]
    s_nop 1
    v_permlane32_swap_b32 v238, v240
    v_mfma_f32_16x16x32_bf16 v[88:91], v[144:147], v[136:139], v[88:91]
    v_permlane32_swap_b32 v239, v241
    buffer_store_dwordx4 v[238:241], v220, s[12:15], s41 offen sc1
    s_add_u32 s41, s41, 110592
    v_mfma_f32_16x16x32_bf16 v[92:95], v[144:147], v[140:143], v[92:95]
    v_permlane32_swap_b32 v112, v116
    v_permlane32_swap_b32 v113, v117
    s_waitcnt lgkmcnt(12)
    s_barrier
    v_mfma_f32_16x16x32_bf16 v[16:19], v[188:191], v[172:175], v[16:19]
    ds_read_b128 v[152:155], v15 offset:14336
    v_permlane32_swap_b32 v114, v118
    v_permlane32_swap_b32 v115, v119
    v_mfma_f32_16x16x32_bf16 v[20:23], v[188:191], v[176:179], v[20:23]
    ds_read_b64_tr_b16 v[128:129], v8 offset:8192
    v_permlane32_swap_b32 v120, v124
    v_permlane32_swap_b32 v121, v125
    v_mfma_f32_16x16x32_bf16 v[24:27], v[188:191], v[180:183], v[24:27]
    ds_read_b64_tr_b16 v[130:131], v8 offset:12288
    v_permlane32_swap_b32 v122, v126
    v_permlane32_swap_b32 v123, v127
    v_mfma_f32_16x16x32_bf16 v[28:31], v[188:191], v[184:187], v[28:31]
    ds_read_b64_tr_b16 v[132:133], v9 offset:8192
    v_pk_mul_f32 v[112:113], v[112:113], v[116:117]
    v_pk_mul_f32 v[114:115], v[114:115], v[118:119]
    v_mfma_f32_16x16x32_bf16 v[64:67], v[192:195], v[172:175], v[64:67]
    ds_read_b64_tr_b16 v[134:135], v9 offset:12288
    v_cvt_pk_bf16_f32 v242, v112, v113
    v_cvt_pk_bf16_f32 v243, v114, v115
    v_mfma_f32_16x16x32_bf16 v[68:71], v[192:195], v[176:179], v[68:71]
    ds_read_b64_tr_b16 v[136:137], v10 offset:8192
    v_pk_mul_f32 v[120:121], v[120:121], v[124:125]
    v_pk_mul_f32 v[122:123], v[122:123], v[126:127]
    v_mfma_f32_16x16x32_bf16 v[72:75], v[192:195], v[180:183], v[72:75]
    ds_read_b64_tr_b16 v[138:139], v10 offset:12288
    v_cvt_pk_bf16_f32 v244, v120, v121
    v_cvt_pk_bf16_f32 v245, v122, v123
    v_mfma_f32_16x16x32_bf16 v[76:79], v[192:195], v[184:187], v[76:79]
    ds_read_b64_tr_b16 v[140:141], v11 offset:8192
    s_nop 1
    v_permlane16_swap_b32 v242, v244
    v_mfma_f32_16x16x32_bf16 v[32:35], v[196:199], v[172:175], v[32:35]
    ds_read_b64_tr_b16 v[142:143], v11 offset:12288
    v_permlane16_swap_b32 v243, v245
    buffer_store_dwordx4 v[242:245], v221, s[12:15], s42 offen sc1
    v_mfma_f32_16x16x32_bf16 v[36:39], v[196:199], v[176:179], v[36:39]
    ds_read_b128 v[164:167], v15 offset:17408
    v_mfma_f32_16x16x32_bf16 v[40:43], v[196:199], v[180:183], v[40:43]
    ds_read_b128 v[168:171], v15 offset:15360
    v_mfma_f32_16x16x32_bf16 v[44:47], v[196:199], v[184:187], v[44:47]
    ds_read_b128 v[144:147], v15 offset:18432
    v_mfma_f32_16x16x32_bf16 v[80:83], v[200:203], v[172:175], v[80:83]
    v_mfma_f32_16x16x32_bf16 v[84:87], v[200:203], v[176:179], v[84:87]
    v_mfma_f32_16x16x32_bf16 v[88:91], v[200:203], v[180:183], v[88:91]
    v_mfma_f32_16x16x32_bf16 v[92:95], v[200:203], v[184:187], v[92:95]
    s_waitcnt lgkmcnt(12)
    v_mfma_f32_16x16x32_bf16 v[16:19], v[248:251], v[204:207], v[16:19]
    ds_read_b128 v[188:191], v15 offset:28672
    v_mfma_f32_16x16x32_bf16 v[20:23], v[248:251], v[208:211], v[20:23]
    ds_read_b64_tr_b16 v[172:173], v8 offset:16384
    v_mfma_f32_16x16x32_bf16 v[24:27], v[248:251], v[212:215], v[24:27]
    ds_read_b64_tr_b16 v[174:175], v8 offset:20480
    v_mfma_f32_16x16x32_bf16 v[28:31], v[248:251], v[216:219], v[28:31]
    ds_read_b64_tr_b16 v[176:177], v9 offset:16384
    v_mfma_f32_16x16x32_bf16 v[64:67], v[148:151], v[204:207], v[64:67]
    ds_read_b64_tr_b16 v[178:179], v9 offset:20480
    v_mfma_f32_16x16x32_bf16 v[68:71], v[148:151], v[208:211], v[68:71]
    ds_read_b64_tr_b16 v[180:181], v10 offset:16384
    v_mfma_f32_16x16x32_bf16 v[72:75], v[148:151], v[212:215], v[72:75]
    ds_read_b64_tr_b16 v[182:183], v10 offset:20480
    v_mfma_f32_16x16x32_bf16 v[76:79], v[148:151], v[216:219], v[76:79]
    ds_read_b64_tr_b16 v[184:185], v11 offset:16384
    v_mfma_f32_16x16x32_bf16 v[32:35], v[156:159], v[204:207], v[32:35]
    ds_read_b64_tr_b16 v[186:187], v11 offset:20480
    v_mfma_f32_16x16x32_bf16 v[36:39], v[156:159], v[208:211], v[36:39]
    ds_read_b128 v[192:195], v15 offset:31744
    v_mfma_f32_16x16x32_bf16 v[40:43], v[156:159], v[212:215], v[40:43]
    ds_read_b128 v[196:199], v15 offset:29696
    v_mfma_f32_16x16x32_bf16 v[44:47], v[156:159], v[216:219], v[44:47]
    ds_read_b128 v[200:203], v15 offset:32768
    v_mfma_f32_16x16x32_bf16 v[80:83], v[160:163], v[204:207], v[80:83]
    v_mfma_f32_16x16x32_bf16 v[84:87], v[160:163], v[208:211], v[84:87]
    v_mfma_f32_16x16x32_bf16 v[88:91], v[160:163], v[212:215], v[88:91]
    v_mfma_f32_16x16x32_bf16 v[92:95], v[160:163], v[216:219], v[92:95]
    s_waitcnt lgkmcnt(12)
    v_mfma_f32_16x16x32_bf16 v[16:19], v[152:155], v[128:131], v[16:19]
    ds_read_b128 v[248:251], v15 offset:43008
    v_mfma_f32_16x16x32_bf16 v[20:23], v[152:155], v[132:135], v[20:23]
    ds_read_b64_tr_b16 v[204:205], v8 offset:24576
    v_mfma_f32_16x16x32_bf16 v[24:27], v[152:155], v[136:139], v[24:27]
    ds_read_b64_tr_b16 v[206:207], v8 offset:28672
    v_mfma_f32_16x16x32_bf16 v[28:31], v[152:155], v[140:143], v[28:31]
    ds_read_b64_tr_b16 v[208:209], v9 offset:24576
    v_mfma_f32_16x16x32_bf16 v[64:67], v[164:167], v[128:131], v[64:67]
    ds_read_b64_tr_b16 v[210:211], v9 offset:28672
    v_mfma_f32_16x16x32_bf16 v[68:71], v[164:167], v[132:135], v[68:71]
    ds_read_b64_tr_b16 v[212:213], v10 offset:24576
    v_mfma_f32_16x16x32_bf16 v[72:75], v[164:167], v[136:139], v[72:75]
    ds_read_b64_tr_b16 v[214:215], v10 offset:28672
    v_mfma_f32_16x16x32_bf16 v[76:79], v[164:167], v[140:143], v[76:79]
    ds_read_b64_tr_b16 v[216:217], v11 offset:24576
    v_mfma_f32_16x16x32_bf16 v[32:35], v[168:171], v[128:131], v[32:35]
    ds_read_b64_tr_b16 v[218:219], v11 offset:28672
    v_mfma_f32_16x16x32_bf16 v[36:39], v[168:171], v[132:135], v[36:39]
    ds_read_b128 v[148:151], v15 offset:46080
    v_mfma_f32_16x16x32_bf16 v[40:43], v[168:171], v[136:139], v[40:43]
    ds_read_b128 v[156:159], v15 offset:44032
    v_mfma_f32_16x16x32_bf16 v[44:47], v[168:171], v[140:143], v[44:47]
    ds_read_b128 v[160:163], v15 offset:47104
    v_mfma_f32_16x16x32_bf16 v[80:83], v[144:147], v[128:131], v[80:83]
    v_mfma_f32_16x16x32_bf16 v[84:87], v[144:147], v[132:135], v[84:87]
    v_mfma_f32_16x16x32_bf16 v[88:91], v[144:147], v[136:139], v[88:91]
    v_mfma_f32_16x16x32_bf16 v[92:95], v[144:147], v[140:143], v[92:95]
    s_waitcnt lgkmcnt(12)
    v_mfma_f32_16x16x32_bf16 v[16:19], v[188:191], v[172:175], v[16:19]
    v_mfma_f32_16x16x32_bf16 v[20:23], v[188:191], v[176:179], v[20:23]
    v_mfma_f32_16x16x32_bf16 v[24:27], v[188:191], v[180:183], v[24:27]
    v_mfma_f32_16x16x32_bf16 v[28:31], v[188:191], v[184:187], v[28:31]
    v_mfma_f32_16x16x32_bf16 v[64:67], v[192:195], v[172:175], v[64:67]
    v_mfma_f32_16x16x32_bf16 v[68:71], v[192:195], v[176:179], v[68:71]
    s_waitcnt lgkmcnt(0)
    s_barrier
    v_mfma_f32_16x16x32_bf16 v[72:75], v[192:195], v[180:183], v[72:75]
    v_mfma_f32_16x16x32_bf16 v[76:79], v[192:195], v[184:187], v[76:79]
    v_mfma_f32_16x16x32_bf16 v[32:35], v[196:199], v[172:175], v[32:35]
    v_mfma_f32_16x16x32_bf16 v[36:39], v[196:199], v[176:179], v[36:39]
    v_mfma_f32_16x16x32_bf16 v[40:43], v[196:199], v[180:183], v[40:43]
    v_mfma_f32_16x16x32_bf16 v[44:47], v[196:199], v[184:187], v[44:47]
    v_mfma_f32_16x16x32_bf16 v[80:83], v[200:203], v[172:175], v[80:83]
    v_mfma_f32_16x16x32_bf16 v[84:87], v[200:203], v[176:179], v[84:87]
    v_mfma_f32_16x16x32_bf16 v[88:91], v[200:203], v[180:183], v[88:91]
    v_mfma_f32_16x16x32_bf16 v[92:95], v[200:203], v[184:187], v[92:95]
    s_waitcnt lgkmcnt(0)
    s_waitcnt vmcnt(0)
    s_mov_b64 exec, 0xffff
    buffer_store_dword v13, v14, s[12:15], s43 offen sc1
    s_mov_b64 exec, -1
    s_nop 1
    v_mfma_f32_16x16x32_bf16 v[16:19], v[248:251], v[204:207], v[16:19]
    v_mfma_f32_16x16x32_bf16 v[64:67], v[148:151], v[204:207], v[64:67]
    v_mfma_f32_16x16x32_bf16 v[32:35], v[156:159], v[204:207], v[32:35]
    v_mfma_f32_16x16x32_bf16 v[80:83], v[160:163], v[204:207], v[80:83]
    v_mfma_f32_16x16x32_bf16 v[20:23], v[248:251], v[208:211], v[20:23]
    v_mfma_f32_16x16x32_bf16 v[68:71], v[148:151], v[208:211], v[68:71]
    v_mfma_f32_16x16x32_bf16 v[36:39], v[156:159], v[208:211], v[36:39]
    v_mfma_f32_16x16x32_bf16 v[84:87], v[160:163], v[208:211], v[84:87]
    v_mfma_f32_16x16x32_bf16 v[24:27], v[248:251], v[212:215], v[24:27]
    v_mfma_f32_16x16x32_bf16 v[72:75], v[148:151], v[212:215], v[72:75]
    v_mfma_f32_16x16x32_bf16 v[40:43], v[156:159], v[212:215], v[40:43]
    v_mfma_f32_16x16x32_bf16 v[88:91], v[160:163], v[212:215], v[88:91]
    v_mfma_f32_16x16x32_bf16 v[28:31], v[248:251], v[216:219], v[28:31]
    v_pk_mul_f32 v[16:17], v[16:17], v[64:65]
    v_pk_mul_f32 v[18:19], v[18:19], v[66:67]
    v_mfma_f32_16x16x32_bf16 v[76:79], v[148:151], v[216:219], v[76:79]
    v_cvt_pk_bf16_f32 v172, v16, v17
    v_cvt_pk_bf16_f32 v173, v18, v19
    v_mfma_f32_16x16x32_bf16 v[44:47], v[156:159], v[216:219], v[44:47]
    v_pk_mul_f32 v[32:33], v[32:33], v[80:81]
    v_pk_mul_f32 v[34:35], v[34:35], v[82:83]
    v_mfma_f32_16x16x32_bf16 v[92:95], v[160:163], v[216:219], v[92:95]
    v_cvt_pk_bf16_f32 v174, v32, v33
    v_cvt_pk_bf16_f32 v175, v34, v35
    buffer_store_dwordx4 v[172:175], v4, s[12:15], s40 offen sc1
    s_add_u32 s40, s40, 55296
    v_pk_mul_f32 v[20:21], v[20:21], v[68:69]
    v_pk_mul_f32 v[22:23], v[22:23], v[70:71]
    v_cvt_pk_bf16_f32 v176, v20, v21
    v_cvt_pk_bf16_f32 v177, v22, v23
    v_pk_mul_f32 v[36:37], v[36:37], v[84:85]
    v_pk_mul_f32 v[38:39], v[38:39], v[86:87]
    v_cvt_pk_bf16_f32 v178, v36, v37
    v_cvt_pk_bf16_f32 v179, v38, v39
    buffer_store_dwordx4 v[176:179], v4, s[12:15], s40 offen sc1
    s_add_u32 s40, s40, 55296
    v_pk_mul_f32 v[24:25], v[24:25], v[72:73]
    v_pk_mul_f32 v[26:27], v[26:27], v[74:75]
    v_cvt_pk_bf16_f32 v180, v24, v25
    v_cvt_pk_bf16_f32 v181, v26, v27
    v_pk_mul_f32 v[40:41], v[40:41], v[88:89]
    v_pk_mul_f32 v[42:43], v[42:43], v[90:91]
    v_cvt_pk_bf16_f32 v182, v40, v41
    v_cvt_pk_bf16_f32 v183, v42, v43
    buffer_store_dwordx4 v[180:183], v4, s[12:15], s40 offen sc1
    s_add_u32 s40, s40, 55296
    v_pk_mul_f32 v[28:29], v[28:29], v[76:77]
    v_pk_mul_f32 v[30:31], v[30:31], v[78:79]
    v_cvt_pk_bf16_f32 v184, v28, v29
    v_cvt_pk_bf16_f32 v185, v30, v31
    v_pk_mul_f32 v[44:45], v[44:45], v[92:93]
    v_pk_mul_f32 v[46:47], v[46:47], v[94:95]
    v_cvt_pk_bf16_f32 v186, v44, v45
    v_cvt_pk_bf16_f32 v187, v46, v47
    buffer_store_dwordx4 v[184:187], v4, s[12:15], s40 offen sc1
    s_add_u32 s40, s40, 55296
K2_FIN:
    v_mov_b64 v[16:17], 0
    v_mov_b64 v[18:19], 0
    v_mov_b64 v[20:21], 0
    v_mov_b64 v[22:23], 0
    v_mov_b64 v[24:25], 0
    v_mov_b64 v[26:27], 0
    v_mov_b64 v[28:29], 0
    v_mov_b64 v[30:31], 0
    v_mov_b64 v[32:33], 0
    v_mov_b64 v[34:35], 0
    v_mov_b64 v[36:37], 0
    v_mov_b64 v[38:39], 0
    v_mov_b64 v[40:41], 0
    v_mov_b64 v[42:43], 0
    v_mov_b64 v[44:45], 0
    v_mov_b64 v[46:47], 0
    v_mov_b64 v[48:49], 0
    v_mov_b64 v[50:51], 0
    v_mov_b64 v[52:53], 0
    v_mov_b64 v[54:55], 0
    s_waitcnt vmcnt(0)
    s_mov_b64 exec, 0xffff
    buffer_store_dword v13, v14, s[12:15], s44 offen sc1
    s_mov_b64 exec, -1
    s_barrier
    buffer_load_dwordx4 v[96:99], v222, s[12:15], s45 offen sc1
    buffer_load_dwordx4 v[100:103], v223, s[12:15], s45 offen sc1
    s_add_u32 s45, s45, 2048
    buffer_load_dwordx4 v[104:107], v222, s[12:15], s45 offen sc1
    buffer_load_dwordx4 v[108:111], v223, s[12:15], s45 offen sc1
    s_add_u32 s45, s45, 2048
    buffer_load_dwordx4 v[112:115], v222, s[12:15], s45 offen sc1
    buffer_load_dwordx4 v[116:119], v223, s[12:15], s45 offen sc1
    s_add_u32 s45, s45, 2048
    buffer_load_dwordx4 v[120:123], v222, s[12:15], s45 offen sc1
    buffer_load_dwordx4 v[124:127], v223, s[12:15], s45 offen sc1
    s_add_u32 s45, s45, 2048
    buffer_load_dwordx4 v[128:131], v222, s[12:15], s45 offen sc1
    buffer_load_dwordx4 v[132:135], v223, s[12:15], s45 offen sc1
    s_add_u32 s45, s45, 2048
    buffer_load_dwordx4 v[136:139], v222, s[12:15], s45 offen sc1
    buffer_load_dwordx4 v[140:143], v223, s[12:15], s45 offen sc1
    s_add_u32 s45, s45, 2048
    ds_read_b128 v[56:59], v224 offset:0
    ds_read_b128 v[60:63], v224 offset:1024
    ds_read_b128 v[64:67], v224 offset:2048
    ds_read_b128 v[68:71], v224 offset:3072
    ds_read_b128 v[72:75], v224 offset:4096
    ds_read_b128 v[76:79], v224 offset:10240
    ds_read_b128 v[80:83], v224 offset:11264
    ds_read_b128 v[84:87], v224 offset:12288
    ds_read_b128 v[88:91], v224 offset:13312
    ds_read_b128 v[92:95], v224 offset:14336
    s_waitcnt vmcnt(10) lgkmcnt(5)
    v_mfma_f32_16x16x32_bf16 v[36:39], v[56:59], v[100:103], v[36:39]
    ds_read_b128 v[168:171], v224 offset:20480
    v_mfma_f32_16x16x32_bf16 v[40:43], v[60:63], v[100:103], v[40:43]
    ds_read_b128 v[172:175], v224 offset:21504
    v_mfma_f32_16x16x32_bf16 v[44:47], v[64:67], v[100:103], v[44:47]
    ds_read_b128 v[176:179], v224 offset:22528
    v_mfma_f32_16x16x32_bf16 v[48:51], v[68:71], v[100:103], v[48:51]
    ds_read_b128 v[180:183], v224 offset:23552
    v_mfma_f32_16x16x32_bf16 v[52:55], v[72:75], v[100:103], v[52:55]
    ds_read_b128 v[184:187], v224 offset:24576
    v_mfma_f32_16x16x32_bf16 v[16:19], v[56:59], v[96:99], v[16:19]
    v_mfma_f32_16x16x32_bf16 v[20:23], v[60:63], v[96:99], v[20:23]
    v_mfma_f32_16x16x32_bf16 v[24:27], v[64:67], v[96:99], v[24:27]
    v_mfma_f32_16x16x32_bf16 v[28:31], v[68:71], v[96:99], v[28:31]
    v_mfma_f32_16x16x32_bf16 v[32:35], v[72:75], v[96:99], v[32:35]
    buffer_load_dwordx4 v[96:99], v222, s[12:15], s45 offen sc1
    buffer_load_dwordx4 v[100:103], v223, s[12:15], s45 offen sc1
    s_add_u32 s45, s45, 2048
    s_waitcnt vmcnt(10) lgkmcnt(5)
    v_mfma_f32_16x16x32_bf16 v[36:39], v[76:79], v[108:111], v[36:39]
    ds_read_b128 v[56:59], v224 offset:30720
    v_mfma_f32_16x16x32_bf16 v[40:43], v[80:83], v[108:111], v[40:43]
    ds_read_b128 v[60:63], v224 offset:31744
    v_mfma_f32_16x16x32_bf16 v[44:47], v[84:87], v[108:111], v[44:47]
    ds_read_b128 v[64:67], v224 offset:32768
    v_mfma_f32_16x16x32_bf16 v[48:51], v[88:91], v[108:111], v[48:51]
    ds_read_b128 v[68:71], v224 offset:33792
    v_mfma_f32_16x16x32_bf16 v[52:55], v[92:95], v[108:111], v[52:55]
    ds_read_b128 v[72:75], v224 offset:34816
    v_mfma_f32_16x16x32_bf16 v[16:19], v[76:79], v[104:107], v[16:19]
    v_mfma_f32_16x16x32_bf16 v[20:23], v[80:83], v[104:107], v[20:23]
    v_mfma_f32_16x16x32_bf16 v[24:27], v[84:87], v[104:107], v[24:27]
    v_mfma_f32_16x16x32_bf16 v[28:31], v[88:91], v[104:107], v[28:31]
    v_mfma_f32_16x16x32_bf16 v[32:35], v[92:95], v[104:107], v[32:35]
    buffer_load_dwordx4 v[104:107], v222, s[12:15], s45 offen sc1
    buffer_load_dwordx4 v[108:111], v223, s[12:15], s45 offen sc1
    s_add_u32 s45, s45, 2048
    s_waitcnt vmcnt(10) lgkmcnt(5)
    v_mfma_f32_16x16x32_bf16 v[36:39], v[168:171], v[116:119], v[36:39]
    ds_read_b128 v[76:79], v224 offset:40960
    v_mfma_f32_16x16x32_bf16 v[40:43], v[172:175], v[116:119], v[40:43]
    ds_read_b128 v[80:83], v224 offset:41984
    v_mfma_f32_16x16x32_bf16 v[44:47], v[176:179], v[116:119], v[44:47]
    ds_read_b128 v[84:87], v224 offset:43008
    v_mfma_f32_16x16x32_bf16 v[48:51], v[180:183], v[116:119], v[48:51]
    ds_read_b128 v[88:91], v224 offset:44032
    v_mfma_f32_16x16x32_bf16 v[52:55], v[184:187], v[116:119], v[52:55]
    ds_read_b128 v[92:95], v224 offset:45056
    v_mfma_f32_16x16x32_bf16 v[16:19], v[168:171], v[112:115], v[16:19]
    v_mfma_f32_16x16x32_bf16 v[20:23], v[172:175], v[112:115], v[20:23]
    v_mfma_f32_16x16x32_bf16 v[24:27], v[176:179], v[112:115], v[24:27]
    v_mfma_f32_16x16x32_bf16 v[28:31], v[180:183], v[112:115], v[28:31]
    v_mfma_f32_16x16x32_bf16 v[32:35], v[184:187], v[112:115], v[32:35]
    buffer_load_dwordx4 v[112:115], v222, s[12:15], s45 offen sc1
    buffer_load_dwordx4 v[116:119], v223, s[12:15], s45 offen sc1
    s_add_u32 s45, s45, 2048
    s_waitcnt vmcnt(10) lgkmcnt(5)
    v_mfma_f32_16x16x32_bf16 v[36:39], v[56:59], v[124:127], v[36:39]
    ds_read_b128 v[168:171], v224 offset:51200
    v_mfma_f32_16x16x32_bf16 v[40:43], v[60:63], v[124:127], v[40:43]
    ds_read_b128 v[172:175], v224 offset:52224
    v_mfma_f32_16x16x32_bf16 v[44:47], v[64:67], v[124:127], v[44:47]
    ds_read_b128 v[176:179], v224 offset:53248
    v_mfma_f32_16x16x32_bf16 v[48:51], v[68:71], v[124:127], v[48:51]
    ds_read_b128 v[180:183], v224 offset:54272
    v_mfma_f32_16x16x32_bf16 v[52:55], v[72:75], v[124:127], v[52:55]
    ds_read_b128 v[184:187], v224 offset:55296
    v_mfma_f32_16x16x32_bf16 v[16:19], v[56:59], v[120:123], v[16:19]
    v_mfma_f32_16x16x32_bf16 v[20:23], v[60:63], v[120:123], v[20:23]
    v_mfma_f32_16x16x32_bf16 v[24:27], v[64:67], v[120:123], v[24:27]
    v_mfma_f32_16x16x32_bf16 v[28:31], v[68:71], v[120:123], v[28:31]
    v_mfma_f32_16x16x32_bf16 v[32:35], v[72:75], v[120:123], v[32:35]
    buffer_load_dwordx4 v[120:123], v222, s[12:15], s45 offen sc1
    buffer_load_dwordx4 v[124:127], v223, s[12:15], s45 offen sc1
    s_add_u32 s45, s45, 2048
    s_waitcnt vmcnt(10) lgkmcnt(5)
    v_mfma_f32_16x16x32_bf16 v[36:39], v[76:79], v[132:135], v[36:39]
    v_mfma_f32_16x16x32_bf16 v[40:43], v[80:83], v[132:135], v[40:43]
    v_mfma_f32_16x16x32_bf16 v[44:47], v[84:87], v[132:135], v[44:47]
    v_mfma_f32_16x16x32_bf16 v[48:51], v[88:91], v[132:135], v[48:51]
    s_waitcnt lgkmcnt(0)
    s_barrier
    v_mfma_f32_16x16x32_bf16 v[52:55], v[92:95], v[132:135], v[52:55]
    ds_read_b128 v[56:59], v225 offset:0
    v_mfma_f32_16x16x32_bf16 v[16:19], v[76:79], v[128:131], v[16:19]
    ds_read_b128 v[60:63], v225 offset:1024
    v_mfma_f32_16x16x32_bf16 v[20:23], v[80:83], v[128:131], v[20:23]
    ds_read_b128 v[64:67], v225 offset:2048
    v_mfma_f32_16x16x32_bf16 v[24:27], v[84:87], v[128:131], v[24:27]
    ds_read_b128 v[68:71], v225 offset:3072
    v_mfma_f32_16x16x32_bf16 v[28:31], v[88:91], v[128:131], v[28:31]
    ds_read_b128 v[72:75], v225 offset:4096
    v_mfma_f32_16x16x32_bf16 v[32:35], v[92:95], v[128:131], v[32:35]
    buffer_load_dwordx4 v[128:131], v222, s[12:15], s45 offen sc1
    buffer_load_dwordx4 v[132:135], v223, s[12:15], s45 offen sc1
    s_add_u32 s45, s45, 2048
    s_waitcnt vmcnt(10) lgkmcnt(5)
    v_mfma_f32_16x16x32_bf16 v[36:39], v[168:171], v[140:143], v[36:39]
    ds_read_b128 v[76:79], v225 offset:10240
    v_mfma_f32_16x16x32_bf16 v[40:43], v[172:175], v[140:143], v[40:43]
    ds_read_b128 v[80:83], v225 offset:11264
    v_mfma_f32_16x16x32_bf16 v[44:47], v[176:179], v[140:143], v[44:47]
    ds_read_b128 v[84:87], v225 offset:12288
    v_mfma_f32_16x16x32_bf16 v[48:51], v[180:183], v[140:143], v[48:51]
    ds_read_b128 v[88:91], v225 offset:13312
    v_mfma_f32_16x16x32_bf16 v[52:55], v[184:187], v[140:143], v[52:55]
    ds_read_b128 v[92:95], v225 offset:14336
    v_mfma_f32_16x16x32_bf16 v[16:19], v[168:171], v[136:139], v[16:19]
    v_mfma_f32_16x16x32_bf16 v[20:23], v[172:175], v[136:139], v[20:23]
    v_mfma_f32_16x16x32_bf16 v[24:27], v[176:179], v[136:139], v[24:27]
    v_mfma_f32_16x16x32_bf16 v[28:31], v[180:183], v[136:139], v[28:31]
    v_mfma_f32_16x16x32_bf16 v[32:35], v[184:187], v[136:139], v[32:35]
    s_waitcnt vmcnt(8) lgkmcnt(5)
    v_mfma_f32_16x16x32_bf16 v[36:39], v[56:59], v[100:103], v[36:39]
    ds_read_b128 v[168:171], v225 offset:20480
    v_mfma_f32_16x16x32_bf16 v[40:43], v[60:63], v[100:103], v[40:43]
    ds_read_b128 v[172:175], v225 offset:21504
    v_mfma_f32_16x16x32_bf16 v[44:47], v[64:67], v[100:103], v[44:47]
    ds_read_b128 v[176:179], v225 offset:22528
    v_mfma_f32_16x16x32_bf16 v[48:51], v[68:71], v[100:103], v[48:51]
    ds_read_b128 v[180:183], v225 offset:23552
    v_mfma_f32_16x16x32_bf16 v[52:55], v[72:75], v[100:103], v[52:55]
    ds_read_b128 v[184:187], v225 offset:24576
    v_mfma_f32_16x16x32_bf16 v[16:19], v[56:59], v[96:99], v[16:19]
    v_mfma_f32_16x16x32_bf16 v[20:23], v[60:63], v[96:99], v[20:23]
    v_mfma_f32_16x16x32_bf16 v[24:27], v[64:67], v[96:99], v[24:27]
    v_mfma_f32_16x16x32_bf16 v[28:31], v[68:71], v[96:99], v[28:31]
    v_mfma_f32_16x16x32_bf16 v[32:35], v[72:75], v[96:99], v[32:35]
    s_waitcnt vmcnt(6) lgkmcnt(5)
    s_barrier
    buffer_load_dwordx4 v[136:139], v222, s[12:15], s45 offen sc1
    buffer_load_dwordx4 v[140:143], v223, s[12:15], s45 offen sc1
    s_add_u32 s45, s45, 2048
    buffer_load_dwordx4 v[96:99], v222, s[12:15], s45 offen sc1
    buffer_load_dwordx4 v[100:103], v223, s[12:15], s45 offen sc1
    s_add_u32 s45, s45, 2048
    buffer_load_dword v164, v228, s[12:15], s46 offen sc1
    v_mfma_f32_16x16x32_bf16 v[36:39], v[76:79], v[108:111], v[36:39]
    ds_read_b128 v[56:59], v225 offset:30720
    v_mfma_f32_16x16x32_bf16 v[40:43], v[80:83], v[108:111], v[40:43]
    ds_read_b128 v[60:63], v225 offset:31744
    v_mfma_f32_16x16x32_bf16 v[44:47], v[84:87], v[108:111], v[44:47]
    ds_read_b128 v[64:67], v225 offset:32768
    v_mfma_f32_16x16x32_bf16 v[48:51], v[88:91], v[108:111], v[48:51]
    ds_read_b128 v[68:71], v225 offset:33792
    v_mfma_f32_16x16x32_bf16 v[52:55], v[92:95], v[108:111], v[52:55]
    ds_read_b128 v[72:75], v225 offset:34816
    v_mfma_f32_16x16x32_bf16 v[16:19], v[76:79], v[104:107], v[16:19]
    v_mfma_f32_16x16x32_bf16 v[20:23], v[80:83], v[104:107], v[20:23]
    v_mfma_f32_16x16x32_bf16 v[24:27], v[84:87], v[104:107], v[24:27]
    v_mfma_f32_16x16x32_bf16 v[28:31], v[88:91], v[104:107], v[28:31]
    v_mfma_f32_16x16x32_bf16 v[32:35], v[92:95], v[104:107], v[32:35]
    buffer_load_dwordx4 v[104:107], v222, s[12:15], s45 offen sc1
    buffer_load_dwordx4 v[108:111], v223, s[12:15], s45 offen sc1
    s_add_u32 s45, s45, 2048
    s_waitcnt vmcnt(11) lgkmcnt(5)
    v_mfma_f32_16x16x32_bf16 v[36:39], v[168:171], v[116:119], v[36:39]
    ds_read_b128 v[76:79], v225 offset:40960
    v_mfma_f32_16x16x32_bf16 v[40:43], v[172:175], v[116:119], v[40:43]
    ds_read_b128 v[80:83], v225 offset:41984
    v_mfma_f32_16x16x32_bf16 v[44:47], v[176:179], v[116:119], v[44:47]
    ds_read_b128 v[84:87], v225 offset:43008
    v_mfma_f32_16x16x32_bf16 v[48:51], v[180:183], v[116:119], v[48:51]
    ds_read_b128 v[88:91], v225 offset:44032
    v_mfma_f32_16x16x32_bf16 v[52:55], v[184:187], v[116:119], v[52:55]
    ds_read_b128 v[92:95], v225 offset:45056
    v_mfma_f32_16x16x32_bf16 v[16:19], v[168:171], v[112:115], v[16:19]
    v_mfma_f32_16x16x32_bf16 v[20:23], v[172:175], v[112:115], v[20:23]
    v_mfma_f32_16x16x32_bf16 v[24:27], v[176:179], v[112:115], v[24:27]
    v_mfma_f32_16x16x32_bf16 v[28:31], v[180:183], v[112:115], v[28:31]
    v_mfma_f32_16x16x32_bf16 v[32:35], v[184:187], v[112:115], v[32:35]
    buffer_load_dwordx4 v[112:115], v222, s[12:15], s45 offen sc1
    buffer_load_dwordx4 v[116:119], v223, s[12:15], s45 offen sc1
    s_add_u32 s45, s45, 2048
    s_waitcnt vmcnt(11) lgkmcnt(5)
    v_mfma_f32_16x16x32_bf16 v[36:39], v[56:59], v[124:127], v[36:39]
    ds_read_b128 v[168:171], v225 offset:51200
    v_mfma_f32_16x16x32_bf16 v[40:43], v[60:63], v[124:127], v[40:43]
    ds_read_b128 v[172:175], v225 offset:52224
    v_mfma_f32_16x16x32_bf16 v[44:47], v[64:67], v[124:127], v[44:47]
    ds_read_b128 v[176:179], v225 offset:53248
    v_mfma_f32_16x16x32_bf16 v[48:51], v[68:71], v[124:127], v[48:51]
    ds_read_b128 v[180:183], v225 offset:54272
    v_mfma_f32_16x16x32_bf16 v[52:55], v[72:75], v[124:127], v[52:55]
    ds_read_b128 v[184:187], v225 offset:55296
    v_mfma_f32_16x16x32_bf16 v[16:19], v[56:59], v[120:123], v[16:19]
    v_mfma_f32_16x16x32_bf16 v[20:23], v[60:63], v[120:123], v[20:23]
    v_mfma_f32_16x16x32_bf16 v[24:27], v[64:67], v[120:123], v[24:27]
    v_mfma_f32_16x16x32_bf16 v[28:31], v[68:71], v[120:123], v[28:31]
    v_mfma_f32_16x16x32_bf16 v[32:35], v[72:75], v[120:123], v[32:35]
    buffer_load_dwordx4 v[120:123], v222, s[12:15], s45 offen sc1
    buffer_load_dwordx4 v[124:127], v223, s[12:15], s45 offen sc1
    s_add_u32 s45, s45, 2048
    s_waitcnt vmcnt(11) lgkmcnt(5)
    v_mfma_f32_16x16x32_bf16 v[36:39], v[76:79], v[132:135], v[36:39]
    ds_read_b128 v[56:59], v226 offset:0
    v_mfma_f32_16x16x32_bf16 v[40:43], v[80:83], v[132:135], v[40:43]
    ds_read_b128 v[60:63], v226 offset:1024
    v_mfma_f32_16x16x32_bf16 v[44:47], v[84:87], v[132:135], v[44:47]
    ds_read_b128 v[64:67], v226 offset:2048
    v_mfma_f32_16x16x32_bf16 v[48:51], v[88:91], v[132:135], v[48:51]
    ds_read_b128 v[68:71], v226 offset:3072
    v_mfma_f32_16x16x32_bf16 v[52:55], v[92:95], v[132:135], v[52:55]
    ds_read_b128 v[72:75], v226 offset:4096
    v_mfma_f32_16x16x32_bf16 v[16:19], v[76:79], v[128:131], v[16:19]
    v_mfma_f32_16x16x32_bf16 v[20:23], v[80:83], v[128:131], v[20:23]
    v_mfma_f32_16x16x32_bf16 v[24:27], v[84:87], v[128:131], v[24:27]
    v_mfma_f32_16x16x32_bf16 v[28:31], v[88:91], v[128:131], v[28:31]
    v_mfma_f32_16x16x32_bf16 v[32:35], v[92:95], v[128:131], v[32:35]
    buffer_load_dwordx4 v[128:131], v222, s[12:15], s45 offen sc1
    buffer_load_dwordx4 v[132:135], v223, s[12:15], s45 offen sc1
    s_add_u32 s45, s45, 2048
    s_waitcnt vmcnt(11) lgkmcnt(5)
    v_mfma_f32_16x16x32_bf16 v[36:39], v[168:171], v[140:143], v[36:39]
    ds_read_b128 v[76:79], v226 offset:10240
    v_mfma_f32_16x16x32_bf16 v[40:43], v[172:175], v[140:143], v[40:43]
    ds_read_b128 v[80:83], v226 offset:11264
    v_mfma_f32_16x16x32_bf16 v[44:47], v[176:179], v[140:143], v[44:47]
    ds_read_b128 v[84:87], v226 offset:12288
    v_mfma_f32_16x16x32_bf16 v[48:51], v[180:183], v[140:143], v[48:51]
    ds_read_b128 v[88:91], v226 offset:13312
    v_mfma_f32_16x16x32_bf16 v[52:55], v[184:187], v[140:143], v[52:55]
    ds_read_b128 v[92:95], v226 offset:14336
    v_mfma_f32_16x16x32_bf16 v[16:19], v[168:171], v[136:139], v[16:19]
    v_mfma_f32_16x16x32_bf16 v[20:23], v[172:175], v[136:139], v[20:23]
    v_mfma_f32_16x16x32_bf16 v[24:27], v[176:179], v[136:139], v[24:27]
    v_mfma_f32_16x16x32_bf16 v[28:31], v[180:183], v[136:139], v[28:31]
    v_mfma_f32_16x16x32_bf16 v[32:35], v[184:187], v[136:139], v[32:35]
    buffer_load_dwordx4 v[136:139], v222, s[12:15], s45 offen sc1
    buffer_load_dwordx4 v[140:143], v223, s[12:15], s45 offen sc1
    s_add_u32 s45, s45, 2048
    s_waitcnt vmcnt(11) lgkmcnt(5)
    v_mfma_f32_16x16x32_bf16 v[36:39], v[56:59], v[100:103], v[36:39]
    ds_read_b128 v[168:171], v226 offset:20480
    v_mfma_f32_16x16x32_bf16 v[40:43], v[60:63], v[100:103], v[40:43]
    ds_read_b128 v[172:175], v226 offset:21504
    v_mfma_f32_16x16x32_bf16 v[44:47], v[64:67], v[100:103], v[44:47]
    ds_read_b128 v[176:179], v226 offset:22528
    v_mfma_f32_16x16x32_bf16 v[48:51], v[68:71], v[100:103], v[48:51]
    ds_read_b128 v[180:183], v226 offset:23552
    v_mfma_f32_16x16x32_bf16 v[52:55], v[72:75], v[100:103], v[52:55]
    ds_read_b128 v[184:187], v226 offset:24576
    v_mfma_f32_16x16x32_bf16 v[16:19], v[56:59], v[96:99], v[16:19]
    v_mfma_f32_16x16x32_bf16 v[20:23], v[60:63], v[96:99], v[20:23]
    v_mfma_f32_16x16x32_bf16 v[24:27], v[64:67], v[96:99], v[24:27]
    v_mfma_f32_16x16x32_bf16 v[28:31], v[68:71], v[96:99], v[28:31]
    v_mfma_f32_16x16x32_bf16 v[32:35], v[72:75], v[96:99], v[32:35]
    buffer_load_dwordx4 v[96:99], v222, s[12:15], s45 offen sc1
    buffer_load_dwordx4 v[100:103], v223, s[12:15], s45 offen sc1
    s_add_u32 s45, s45, 2048
    s_waitcnt vmcnt(10) lgkmcnt(5)
    v_mfma_f32_16x16x32_bf16 v[36:39], v[76:79], v[108:111], v[36:39]
    v_mfma_f32_16x16x32_bf16 v[40:43], v[80:83], v[108:111], v[40:43]
    v_mfma_f32_16x16x32_bf16 v[44:47], v[84:87], v[108:111], v[44:47]
    v_mfma_f32_16x16x32_bf16 v[48:51], v[88:91], v[108:111], v[48:51]
    s_waitcnt lgkmcnt(0)
    s_barrier
    v_mfma_f32_16x16x32_bf16 v[52:55], v[92:95], v[108:111], v[52:55]
    ds_read_b128 v[56:59], v224 offset:0
    v_mfma_f32_16x16x32_bf16 v[16:19], v[76:79], v[104:107], v[16:19]
    ds_read_b128 v[60:63], v224 offset:1024
    v_mfma_f32_16x16x32_bf16 v[20:23], v[80:83], v[104:107], v[20:23]
    ds_read_b128 v[64:67], v224 offset:2048
    v_mfma_f32_16x16x32_bf16 v[24:27], v[84:87], v[104:107], v[24:27]
    ds_read_b128 v[68:71], v224 offset:3072
    v_mfma_f32_16x16x32_bf16 v[28:31], v[88:91], v[104:107], v[28:31]
    ds_read_b128 v[72:75], v224 offset:4096
    v_mfma_f32_16x16x32_bf16 v[32:35], v[92:95], v[104:107], v[32:35]
    buffer_load_dwordx4 v[104:107], v222, s[12:15], s45 offen sc1
    buffer_load_dwordx4 v[108:111], v223, s[12:15], s45 offen sc1
    s_add_u32 s45, s45, 2048
    s_waitcnt vmcnt(10) lgkmcnt(5)
    v_mfma_f32_16x16x32_bf16 v[36:39], v[168:171], v[116:119], v[36:39]
    ds_read_b128 v[76:79], v224 offset:10240
    v_mfma_f32_16x16x32_bf16 v[40:43], v[172:175], v[116:119], v[40:43]
    ds_read_b128 v[80:83], v224 offset:11264
    v_mfma_f32_16x16x32_bf16 v[44:47], v[176:179], v[116:119], v[44:47]
    ds_read_b128 v[84:87], v224 offset:12288
    v_mfma_f32_16x16x32_bf16 v[48:51], v[180:183], v[116:119], v[48:51]
    ds_read_b128 v[88:91], v224 offset:13312
    v_mfma_f32_16x16x32_bf16 v[52:55], v[184:187], v[116:119], v[52:55]
    ds_read_b128 v[92:95], v224 offset:14336
    v_mfma_f32_16x16x32_bf16 v[16:19], v[168:171], v[112:115], v[16:19]
    v_mfma_f32_16x16x32_bf16 v[20:23], v[172:175], v[112:115], v[20:23]
    v_mfma_f32_16x16x32_bf16 v[24:27], v[176:179], v[112:115], v[24:27]
    v_mfma_f32_16x16x32_bf16 v[28:31], v[180:183], v[112:115], v[28:31]
    v_mfma_f32_16x16x32_bf16 v[32:35], v[184:187], v[112:115], v[32:35]
    buffer_load_dwordx4 v[112:115], v222, s[12:15], s45 offen sc1
    buffer_load_dwordx4 v[116:119], v223, s[12:15], s45 offen sc1
    s_add_u32 s45, s45, 2048
    s_waitcnt vmcnt(10) lgkmcnt(5)
    v_mfma_f32_16x16x32_bf16 v[36:39], v[56:59], v[124:127], v[36:39]
    ds_read_b128 v[168:171], v224 offset:20480
    v_mfma_f32_16x16x32_bf16 v[40:43], v[60:63], v[124:127], v[40:43]
    ds_read_b128 v[172:175], v224 offset:21504
    v_mfma_f32_16x16x32_bf16 v[44:47], v[64:67], v[124:127], v[44:47]
    ds_read_b128 v[176:179], v224 offset:22528
    v_mfma_f32_16x16x32_bf16 v[48:51], v[68:71], v[124:127], v[48:51]
    ds_read_b128 v[180:183], v224 offset:23552
    v_mfma_f32_16x16x32_bf16 v[52:55], v[72:75], v[124:127], v[52:55]
    ds_read_b128 v[184:187], v224 offset:24576
    v_mfma_f32_16x16x32_bf16 v[16:19], v[56:59], v[120:123], v[16:19]
    v_mfma_f32_16x16x32_bf16 v[20:23], v[60:63], v[120:123], v[20:23]
    v_mfma_f32_16x16x32_bf16 v[24:27], v[64:67], v[120:123], v[24:27]
    v_mfma_f32_16x16x32_bf16 v[28:31], v[68:71], v[120:123], v[28:31]
    v_mfma_f32_16x16x32_bf16 v[32:35], v[72:75], v[120:123], v[32:35]
    buffer_load_dwordx4 v[120:123], v222, s[12:15], s45 offen sc1
    buffer_load_dwordx4 v[124:127], v223, s[12:15], s45 offen sc1
    s_add_u32 s45, s45, 2048
    s_waitcnt vmcnt(10) lgkmcnt(5)
    v_mfma_f32_16x16x32_bf16 v[36:39], v[76:79], v[132:135], v[36:39]
    ds_read_b128 v[56:59], v224 offset:30720
    v_mfma_f32_16x16x32_bf16 v[40:43], v[80:83], v[132:135], v[40:43]
    ds_read_b128 v[60:63], v224 offset:31744
    v_mfma_f32_16x16x32_bf16 v[44:47], v[84:87], v[132:135], v[44:47]
    ds_read_b128 v[64:67], v224 offset:32768
    v_mfma_f32_16x16x32_bf16 v[48:51], v[88:91], v[132:135], v[48:51]
    ds_read_b128 v[68:71], v224 offset:33792
    v_mfma_f32_16x16x32_bf16 v[52:55], v[92:95], v[132:135], v[52:55]
    ds_read_b128 v[72:75], v224 offset:34816
    v_mfma_f32_16x16x32_bf16 v[16:19], v[76:79], v[128:131], v[16:19]
    v_mfma_f32_16x16x32_bf16 v[20:23], v[80:83], v[128:131], v[20:23]
    v_mfma_f32_16x16x32_bf16 v[24:27], v[84:87], v[128:131], v[24:27]
    v_mfma_f32_16x16x32_bf16 v[28:31], v[88:91], v[128:131], v[28:31]
    v_mfma_f32_16x16x32_bf16 v[32:35], v[92:95], v[128:131], v[32:35]
    buffer_load_dwordx4 v[128:131], v222, s[12:15], s45 offen sc1
    buffer_load_dwordx4 v[132:135], v223, s[12:15], s45 offen sc1
    s_add_u32 s45, s45, 2048
    s_waitcnt vmcnt(10) lgkmcnt(5)
    v_mfma_f32_16x16x32_bf16 v[36:39], v[168:171], v[140:143], v[36:39]
    ds_read_b128 v[76:79], v224 offset:40960
    v_mfma_f32_16x16x32_bf16 v[40:43], v[172:175], v[140:143], v[40:43]
    ds_read_b128 v[80:83], v224 offset:41984
    v_mfma_f32_16x16x32_bf16 v[44:47], v[176:179], v[140:143], v[44:47]
    ds_read_b128 v[84:87], v224 offset:43008
    v_mfma_f32_16x16x32_bf16 v[48:51], v[180:183], v[140:143], v[48:51]
    ds_read_b128 v[88:91], v224 offset:44032
    v_mfma_f32_16x16x32_bf16 v[52:55], v[184:187], v[140:143], v[52:55]
    ds_read_b128 v[92:95], v224 offset:45056
    v_mfma_f32_16x16x32_bf16 v[16:19], v[168:171], v[136:139], v[16:19]
    v_mfma_f32_16x16x32_bf16 v[20:23], v[172:175], v[136:139], v[20:23]
    v_mfma_f32_16x16x32_bf16 v[24:27], v[176:179], v[136:139], v[24:27]
    v_mfma_f32_16x16x32_bf16 v[28:31], v[180:183], v[136:139], v[28:31]
    v_mfma_f32_16x16x32_bf16 v[32:35], v[184:187], v[136:139], v[32:35]
    buffer_load_dwordx4 v[136:139], v222, s[12:15], s45 offen sc1
    buffer_load_dwordx4 v[140:143], v223, s[12:15], s45 offen sc1
    s_add_u32 s45, s45, 2048
    s_waitcnt vmcnt(10) lgkmcnt(5)
    v_mfma_f32_16x16x32_bf16 v[36:39], v[56:59], v[100:103], v[36:39]
    ds_read_b128 v[168:171], v224 offset:51200
    v_mfma_f32_16x16x32_bf16 v[40:43], v[60:63], v[100:103], v[40:43]
    ds_read_b128 v[172:175], v224 offset:52224
    v_mfma_f32_16x16x32_bf16 v[44:47], v[64:67], v[100:103], v[44:47]
    ds_read_b128 v[176:179], v224 offset:53248
    v_mfma_f32_16x16x32_bf16 v[48:51], v[68:71], v[100:103], v[48:51]
    ds_read_b128 v[180:183], v224 offset:54272
    v_mfma_f32_16x16x32_bf16 v[52:55], v[72:75], v[100:103], v[52:55]
    ds_read_b128 v[184:187], v224 offset:55296
    v_mfma_f32_16x16x32_bf16 v[16:19], v[56:59], v[96:99], v[16:19]
    v_mfma_f32_16x16x32_bf16 v[20:23], v[60:63], v[96:99], v[20:23]
    v_mfma_f32_16x16x32_bf16 v[24:27], v[64:67], v[96:99], v[24:27]
    v_mfma_f32_16x16x32_bf16 v[28:31], v[68:71], v[96:99], v[28:31]
    v_mfma_f32_16x16x32_bf16 v[32:35], v[72:75], v[96:99], v[32:35]
    buffer_load_dwordx4 v[96:99], v222, s[12:15], s45 offen sc1
    buffer_load_dwordx4 v[100:103], v223, s[12:15], s45 offen sc1
    s_add_u32 s45, s45, 2048
    s_waitcnt vmcnt(10) lgkmcnt(5)
    v_mfma_f32_16x16x32_bf16 v[36:39], v[76:79], v[108:111], v[36:39]
    v_mfma_f32_16x16x32_bf16 v[40:43], v[80:83], v[108:111], v[40:43]
    v_mfma_f32_16x16x32_bf16 v[44:47], v[84:87], v[108:111], v[44:47]
    v_mfma_f32_16x16x32_bf16 v[48:51], v[88:91], v[108:111], v[48:51]
    s_waitcnt lgkmcnt(0)
    s_barrier
    v_mfma_f32_16x16x32_bf16 v[52:55], v[92:95], v[108:111], v[52:55]
    ds_read_b128 v[56:59], v225 offset:0
    v_mfma_f32_16x16x32_bf16 v[16:19], v[76:79], v[104:107], v[16:19]
    ds_read_b128 v[60:63], v225 offset:1024
    v_mfma_f32_16x16x32_bf16 v[20:23], v[80:83], v[104:107], v[20:23]
    ds_read_b128 v[64:67], v225 offset:2048
    v_mfma_f32_16x16x32_bf16 v[24:27], v[84:87], v[104:107], v[24:27]
    ds_read_b128 v[68:71], v225 offset:3072
    v_mfma_f32_16x16x32_bf16 v[28:31], v[88:91], v[104:107], v[28:31]
    ds_read_b128 v[72:75], v225 offset:4096
    v_mfma_f32_16x16x32_bf16 v[32:35], v[92:95], v[104:107], v[32:35]
    buffer_load_dwordx4 v[104:107], v222, s[12:15], s45 offen sc1
    buffer_load_dwordx4 v[108:111], v223, s[12:15], s45 offen sc1
    s_add_u32 s45, s45, 2048
    s_waitcnt vmcnt(10) lgkmcnt(5)
    v_mfma_f32_16x16x32_bf16 v[36:39], v[168:171], v[116:119], v[36:39]
    ds_read_b128 v[76:79], v225 offset:10240
    v_mfma_f32_16x16x32_bf16 v[40:43], v[172:175], v[116:119], v[40:43]
    ds_read_b128 v[80:83], v225 offset:11264
    v_mfma_f32_16x16x32_bf16 v[44:47], v[176:179], v[116:119], v[44:47]
    ds_read_b128 v[84:87], v225 offset:12288
    v_mfma_f32_16x16x32_bf16 v[48:51], v[180:183], v[116:119], v[48:51]
    ds_read_b128 v[88:91], v225 offset:13312
    v_mfma_f32_16x16x32_bf16 v[52:55], v[184:187], v[116:119], v[52:55]
    ds_read_b128 v[92:95], v225 offset:14336
    v_mfma_f32_16x16x32_bf16 v[16:19], v[168:171], v[112:115], v[16:19]
    v_mfma_f32_16x16x32_bf16 v[20:23], v[172:175], v[112:115], v[20:23]
    v_mfma_f32_16x16x32_bf16 v[24:27], v[176:179], v[112:115], v[24:27]
    v_mfma_f32_16x16x32_bf16 v[28:31], v[180:183], v[112:115], v[28:31]
    v_mfma_f32_16x16x32_bf16 v[32:35], v[184:187], v[112:115], v[32:35]
    buffer_load_dwordx4 v[112:115], v222, s[12:15], s45 offen sc1
    buffer_load_dwordx4 v[116:119], v223, s[12:15], s45 offen sc1
    s_add_u32 s45, s45, 2048
    s_waitcnt vmcnt(10) lgkmcnt(5)
    v_mfma_f32_16x16x32_bf16 v[36:39], v[56:59], v[124:127], v[36:39]
    ds_read_b128 v[168:171], v225 offset:20480
    v_mfma_f32_16x16x32_bf16 v[40:43], v[60:63], v[124:127], v[40:43]
    ds_read_b128 v[172:175], v225 offset:21504
    v_mfma_f32_16x16x32_bf16 v[44:47], v[64:67], v[124:127], v[44:47]
    ds_read_b128 v[176:179], v225 offset:22528
    v_mfma_f32_16x16x32_bf16 v[48:51], v[68:71], v[124:127], v[48:51]
    ds_read_b128 v[180:183], v225 offset:23552
    v_mfma_f32_16x16x32_bf16 v[52:55], v[72:75], v[124:127], v[52:55]
    ds_read_b128 v[184:187], v225 offset:24576
    v_mfma_f32_16x16x32_bf16 v[16:19], v[56:59], v[120:123], v[16:19]
    v_mfma_f32_16x16x32_bf16 v[20:23], v[60:63], v[120:123], v[20:23]
    v_mfma_f32_16x16x32_bf16 v[24:27], v[64:67], v[120:123], v[24:27]
    v_mfma_f32_16x16x32_bf16 v[28:31], v[68:71], v[120:123], v[28:31]
    v_mfma_f32_16x16x32_bf16 v[32:35], v[72:75], v[120:123], v[32:35]
    s_waitcnt vmcnt(8) lgkmcnt(5)
    v_mfma_f32_16x16x32_bf16 v[36:39], v[76:79], v[132:135], v[36:39]
    ds_read_b128 v[56:59], v225 offset:30720
    v_mfma_f32_16x16x32_bf16 v[40:43], v[80:83], v[132:135], v[40:43]
    ds_read_b128 v[60:63], v225 offset:31744
    v_mfma_f32_16x16x32_bf16 v[44:47], v[84:87], v[132:135], v[44:47]
    ds_read_b128 v[64:67], v225 offset:32768
    v_mfma_f32_16x16x32_bf16 v[48:51], v[88:91], v[132:135], v[48:51]
    ds_read_b128 v[68:71], v225 offset:33792
    v_mfma_f32_16x16x32_bf16 v[52:55], v[92:95], v[132:135], v[52:55]
    ds_read_b128 v[72:75], v225 offset:34816
    v_mfma_f32_16x16x32_bf16 v[16:19], v[76:79], v[128:131], v[16:19]
    v_mfma_f32_16x16x32_bf16 v[20:23], v[80:83], v[128:131], v[20:23]
    v_mfma_f32_16x16x32_bf16 v[24:27], v[84:87], v[128:131], v[24:27]
    v_mfma_f32_16x16x32_bf16 v[28:31], v[88:91], v[128:131], v[28:31]
    v_mfma_f32_16x16x32_bf16 v[32:35], v[92:95], v[128:131], v[32:35]
    s_waitcnt vmcnt(6) lgkmcnt(5)
    v_mfma_f32_16x16x32_bf16 v[36:39], v[168:171], v[140:143], v[36:39]
    ds_read_b128 v[76:79], v225 offset:40960
    v_mfma_f32_16x16x32_bf16 v[40:43], v[172:175], v[140:143], v[40:43]
    ds_read_b128 v[80:83], v225 offset:41984
    v_mfma_f32_16x16x32_bf16 v[44:47], v[176:179], v[140:143], v[44:47]
    ds_read_b128 v[84:87], v225 offset:43008
    v_mfma_f32_16x16x32_bf16 v[48:51], v[180:183], v[140:143], v[48:51]
    ds_read_b128 v[88:91], v225 offset:44032
    v_mfma_f32_16x16x32_bf16 v[52:55], v[184:187], v[140:143], v[52:55]
    ds_read_b128 v[92:95], v225 offset:45056
    v_mfma_f32_16x16x32_bf16 v[16:19], v[168:171], v[136:139], v[16:19]
    v_mfma_f32_16x16x32_bf16 v[20:23], v[172:175], v[136:139], v[20:23]
    v_mfma_f32_16x16x32_bf16 v[24:27], v[176:179], v[136:139], v[24:27]
    v_mfma_f32_16x16x32_bf16 v[28:31], v[180:183], v[136:139], v[28:31]
    v_mfma_f32_16x16x32_bf16 v[32:35], v[184:187], v[136:139], v[32:35]
    s_waitcnt vmcnt(4) lgkmcnt(5)
    v_mfma_f32_16x16x32_bf16 v[36:39], v[56:59], v[100:103], v[36:39]
    ds_read_b128 v[168:171], v225 offset:51200
    v_mfma_f32_16x16x32_bf16 v[40:43], v[60:63], v[100:103], v[40:43]
    ds_read_b128 v[172:175], v225 offset:52224
    v_mfma_f32_16x16x32_bf16 v[44:47], v[64:67], v[100:103], v[44:47]
    ds_read_b128 v[176:179], v225 offset:53248
    v_mfma_f32_16x16x32_bf16 v[48:51], v[68:71], v[100:103], v[48:51]
    ds_read_b128 v[180:183], v225 offset:54272
    v_mfma_f32_16x16x32_bf16 v[52:55], v[72:75], v[100:103], v[52:55]
    ds_read_b128 v[184:187], v225 offset:55296
    v_mfma_f32_16x16x32_bf16 v[16:19], v[56:59], v[96:99], v[16:19]
    v_mfma_f32_16x16x32_bf16 v[20:23], v[60:63], v[96:99], v[20:23]
    v_mfma_f32_16x16x32_bf16 v[24:27], v[64:67], v[96:99], v[24:27]
    v_mfma_f32_16x16x32_bf16 v[28:31], v[68:71], v[96:99], v[28:31]
    v_mfma_f32_16x16x32_bf16 v[32:35], v[72:75], v[96:99], v[32:35]
    s_waitcnt vmcnt(2) lgkmcnt(5)
    v_mfma_f32_16x16x32_bf16 v[36:39], v[76:79], v[108:111], v[36:39]
    ds_read_b64_tr_b16 v[188:189], v227 offset:0
    v_mfma_f32_16x16x32_bf16 v[40:43], v[80:83], v[108:111], v[40:43]
    ds_read_b64_tr_b16 v[190:191], v227 offset:2048
    v_mfma_f32_16x16x32_bf16 v[44:47], v[84:87], v[108:111], v[44:47]
    ds_read_b64_tr_b16 v[192:193], v227 offset:4096
    v_mfma_f32_16x16x32_bf16 v[48:51], v[88:91], v[108:111], v[48:51]
    ds_read_b64_tr_b16 v[194:195], v227 offset:6144
    v_mfma_f32_16x16x32_bf16 v[52:55], v[92:95], v[108:111], v[52:55]
    ds_read_b64_tr_b16 v[196:197], v227 offset:8192
    v_mfma_f32_16x16x32_bf16 v[16:19], v[76:79], v[104:107], v[16:19]
    v_mfma_f32_16x16x32_bf16 v[20:23], v[80:83], v[104:107], v[20:23]
    v_mfma_f32_16x16x32_bf16 v[24:27], v[84:87], v[104:107], v[24:27]
    v_mfma_f32_16x16x32_bf16 v[28:31], v[88:91], v[104:107], v[28:31]
    v_mfma_f32_16x16x32_bf16 v[32:35], v[92:95], v[104:107], v[32:35]
    s_waitcnt vmcnt(0) lgkmcnt(0)
    v_mfma_f32_16x16x32_bf16 v[36:39], v[168:171], v[116:119], v[36:39]
    v_lshlrev_b32 v144, 16, v188
    v_and_b32 v145, 0xffff0000, v188
    v_mfma_f32_16x16x32_bf16 v[40:43], v[172:175], v[116:119], v[40:43]
    v_lshlrev_b32 v146, 16, v189
    v_and_b32 v147, 0xffff0000, v189
    v_mfma_f32_16x16x32_bf16 v[44:47], v[176:179], v[116:119], v[44:47]
    v_lshlrev_b32 v148, 16, v190
    v_and_b32 v149, 0xffff0000, v190
    v_mfma_f32_16x16x32_bf16 v[48:51], v[180:183], v[116:119], v[48:51]
    v_lshlrev_b32 v150, 16, v191
    v_and_b32 v151, 0xffff0000, v191
    v_mfma_f32_16x16x32_bf16 v[52:55], v[184:187], v[116:119], v[52:55]
    v_lshlrev_b32 v152, 16, v192
    v_and_b32 v153, 0xffff0000, v192
    v_mfma_f32_16x16x32_bf16 v[16:19], v[168:171], v[112:115], v[16:19]
    v_lshlrev_b32 v154, 16, v193
    v_and_b32 v155, 0xffff0000, v193
    v_mfma_f32_16x16x32_bf16 v[20:23], v[172:175], v[112:115], v[20:23]
    v_lshlrev_b32 v156, 16, v194
    v_and_b32 v157, 0xffff0000, v194
    v_mfma_f32_16x16x32_bf16 v[24:27], v[176:179], v[112:115], v[24:27]
    v_lshlrev_b32 v158, 16, v195
    v_and_b32 v159, 0xffff0000, v195
    v_mfma_f32_16x16x32_bf16 v[28:31], v[180:183], v[112:115], v[28:31]
    v_lshlrev_b32 v160, 16, v196
    v_and_b32 v161, 0xffff0000, v196
    v_mfma_f32_16x16x32_bf16 v[32:35], v[184:187], v[112:115], v[32:35]
    v_lshlrev_b32 v162, 16, v197
    v_and_b32 v163, 0xffff0000, v197
    s_nop 2
    ds_write_b128 v232, v[36:39] offset:0
    ds_write_b128 v232, v[40:43] offset:1024
    ds_write_b128 v232, v[44:47] offset:2048
    ds_write_b128 v232, v[48:51] offset:3072
    ds_write_b128 v232, v[52:55] offset:4096
    s_waitcnt lgkmcnt(0)
    s_barrier
    ds_read_b128 v[56:59], v231 offset:0
    ds_read_b128 v[60:63], v231 offset:1024
    ds_read_b128 v[64:67], v231 offset:2048
    ds_read_b128 v[68:71], v231 offset:3072
    ds_read_b128 v[72:75], v231 offset:4096
    s_waitcnt lgkmcnt(4)
    v_pk_add_f32 v[16:17], v[16:17], v[56:57]
    v_pk_add_f32 v[18:19], v[18:19], v[58:59]
    v_pk_fma_f32 v[16:17], v[16:17], v[164:165], v[144:145] op_sel_hi:[1,0,1]
    v_pk_fma_f32 v[18:19], v[18:19], v[164:165], v[146:147] op_sel_hi:[1,0,1]
    v_cvt_pk_bf16_f32 v80, v16, v17
    v_cvt_pk_bf16_f32 v81, v18, v19
    s_waitcnt lgkmcnt(3)
    v_pk_add_f32 v[20:21], v[20:21], v[60:61]
    v_pk_add_f32 v[22:23], v[22:23], v[62:63]
    v_pk_fma_f32 v[20:21], v[20:21], v[164:165], v[148:149] op_sel_hi:[1,0,1]
    v_pk_fma_f32 v[22:23], v[22:23], v[164:165], v[150:151] op_sel_hi:[1,0,1]
    v_cvt_pk_bf16_f32 v82, v20, v21
    v_cvt_pk_bf16_f32 v83, v22, v23
    s_nop 1
    v_permlane16_swap_b32 v80, v82
    v_permlane16_swap_b32 v81, v83
    buffer_store_dwordx4 v[80:83], v230, s[8:11], s47 offen offset:0
    s_waitcnt lgkmcnt(2)
    v_pk_add_f32 v[24:25], v[24:25], v[64:65]
    v_pk_add_f32 v[26:27], v[26:27], v[66:67]
    v_pk_fma_f32 v[24:25], v[24:25], v[164:165], v[152:153] op_sel_hi:[1,0,1]
    v_pk_fma_f32 v[26:27], v[26:27], v[164:165], v[154:155] op_sel_hi:[1,0,1]
    v_cvt_pk_bf16_f32 v84, v24, v25
    v_cvt_pk_bf16_f32 v85, v26, v27
    s_waitcnt lgkmcnt(1)
    v_pk_add_f32 v[28:29], v[28:29], v[68:69]
    v_pk_add_f32 v[30:31], v[30:31], v[70:71]
    v_pk_fma_f32 v[28:29], v[28:29], v[164:165], v[156:157] op_sel_hi:[1,0,1]
    v_pk_fma_f32 v[30:31], v[30:31], v[164:165], v[158:159] op_sel_hi:[1,0,1]
    v_cvt_pk_bf16_f32 v86, v28, v29
    v_cvt_pk_bf16_f32 v87, v30, v31
    s_nop 1
    v_permlane16_swap_b32 v84, v86
    v_permlane16_swap_b32 v85, v87
    buffer_store_dwordx4 v[84:87], v230, s[8:11], s47 offen offset:64
    s_waitcnt lgkmcnt(0)
    v_pk_add_f32 v[32:33], v[32:33], v[72:73]
    v_pk_add_f32 v[34:35], v[34:35], v[74:75]
    v_pk_fma_f32 v[32:33], v[32:33], v[164:165], v[160:161] op_sel_hi:[1,0,1]
    v_pk_fma_f32 v[34:35], v[34:35], v[164:165], v[162:163] op_sel_hi:[1,0,1]
    v_cvt_pk_bf16_f32 v88, v32, v33
    v_cvt_pk_bf16_f32 v89, v34, v35
    buffer_store_dwordx2 v[88:89], v229, s[8:11], s47 offen offset:128
    s_endpgm
K2_STAT:
    s_mov_b64 exec, 0xffff
    buffer_store_dword v13, v14, s[12:15], s43 offen sc1
    s_mov_b64 exec, -1
    s_nop 1
    .p2align 3
K2_SLOOP:
    s_waitcnt lgkmcnt(0)
    s_add_u32 s27, s27, 1
    v_mfma_f32_16x16x32_bf16 v[16:19], v[128:131], v[128:131], v[16:19]
    ds_read_b64_tr_b16 v[172:173], v8 offset:8192
    ds_read_b64_tr_b16 v[174:175], v8 offset:12288
    v_mfma_f32_16x16x32_bf16 v[20:23], v[132:135], v[132:135], v[20:23]
    ds_read_b64_tr_b16 v[176:177], v9 offset:8192
    ds_read_b64_tr_b16 v[178:179], v9 offset:12288
    v_mfma_f32_16x16x32_bf16 v[24:27], v[136:139], v[136:139], v[24:27]
    ds_read_b64_tr_b16 v[180:181], v10 offset:8192
    ds_read_b64_tr_b16 v[182:183], v10 offset:12288
    v_mfma_f32_16x16x32_bf16 v[28:31], v[140:143], v[140:143], v[28:31]
    ds_read_b64_tr_b16 v[184:185], v11 offset:8192
    v_mfma_f32_16x16x32_bf16 v[32:35], v[216:219], v[128:131], v[32:35]
    ds_read_b64_tr_b16 v[186:187], v11 offset:12288
    s_add_u32 s28, s28, 1
    s_cmp_eq_u32 s28, 3
    v_mfma_f32_16x16x32_bf16 v[36:39], v[216:219], v[132:135], v[36:39]
    s_cselect_b32 s30, 0xffff8000, s33
    s_cselect_b32 s31, 0xffff2000, s34
    v_mfma_f32_16x16x32_bf16 v[40:43], v[216:219], v[136:139], v[40:43]
    s_cselect_b32 s28, 0, s28
    v_add_u32 v8, s30, v8
    v_add_u32 v9, s30, v9
    v_add_u32 v10, s30, v10
    v_mfma_f32_16x16x32_bf16 v[44:47], v[216:219], v[140:143], v[44:47]
    v_add_u32 v11, s30, v11
    v_add_u32 v12, s31, v12
    s_waitcnt lgkmcnt(0)
    s_cmp_lt_u32 s27, 10
    s_cbranch_scc0 K2_SLOOP_T
    s_barrier
    v_mfma_f32_16x16x32_bf16 v[16:19], v[172:175], v[172:175], v[16:19]
    ds_read_b64_tr_b16 v[128:129], v8 offset:0
    v_mfma_f32_16x16x32_bf16 v[20:23], v[176:179], v[176:179], v[20:23]
    ds_read_b64_tr_b16 v[130:131], v8 offset:4096
    v_mfma_f32_16x16x32_bf16 v[24:27], v[180:183], v[180:183], v[24:27]
    ds_read_b64_tr_b16 v[132:133], v9 offset:0
    v_mfma_f32_16x16x32_bf16 v[28:31], v[184:187], v[184:187], v[28:31]
    ds_read_b64_tr_b16 v[134:135], v9 offset:4096
    v_mfma_f32_16x16x32_bf16 v[32:35], v[216:219], v[172:175], v[32:35]
    ds_read_b64_tr_b16 v[136:137], v10 offset:0
    v_mfma_f32_16x16x32_bf16 v[36:39], v[216:219], v[176:179], v[36:39]
    ds_read_b64_tr_b16 v[138:139], v10 offset:4096
    v_mfma_f32_16x16x32_bf16 v[40:43], v[216:219], v[180:183], v[40:43]
    ds_read_b64_tr_b16 v[140:141], v11 offset:0
    v_mfma_f32_16x16x32_bf16 v[44:47], v[216:219], v[184:187], v[44:47]
    ds_read_b64_tr_b16 v[142:143], v11 offset:4096
    s_branch K2_SLOOP
K2_SLOOP_T:
    s_barrier
    s_barrier
    v_mfma_f32_16x16x32_bf16 v[16:19], v[172:175], v[172:175], v[16:19]
    v_mfma_f32_16x16x32_bf16 v[20:23], v[176:179], v[176:179], v[20:23]
    v_mfma_f32_16x16x32_bf16 v[24:27], v[180:183], v[180:183], v[24:27]
    v_mfma_f32_16x16x32_bf16 v[28:31], v[184:187], v[184:187], v[28:31]
    v_mfma_f32_16x16x32_bf16 v[32:35], v[216:219], v[172:175], v[32:35]
    v_mfma_f32_16x16x32_bf16 v[36:39], v[216:219], v[176:179], v[36:39]
    v_mfma_f32_16x16x32_bf16 v[40:43], v[216:219], v[180:183], v[40:43]
    v_mfma_f32_16x16x32_bf16 v[44:47], v[216:219], v[184:187], v[44:47]
    v_and_b32 v5, 3, v1
    v_bfe_u32 v6, v1, 2, 2
    v_lshrrev_b32 v7, 4, v1
    v_cmp_eq_u32 s[20:21], 1, v5
    v_cmp_eq_u32 s[22:23], 2, v5
    v_cmp_eq_u32 s[24:25], 3, v5
    v_cmp_eq_u32 s[26:27], v6, v7
    v_and_b32 v5, 15, v1
    v_lshlrev_b32 v5, 2, v5
    s_lshl_b32 s28, s16, 9
    s_lshl_b32 s29, s18, 8
    s_add_u32 s28, s28, s29
    s_add_u32 s28, s28, 0x8000
    v_cndmask_b32 v16, v16, v17, s[20:21]
    v_cndmask_b32 v16, v16, v18, s[22:23]
    v_cndmask_b32 v16, v16, v19, s[24:25]
    v_mul_f32 v32, 0x3acccccd, v32
    v_mul_f32 v16, 0x3acccccd, v16
    v_fma_f32 v16, -v32, v32, v16
    v_max_f32 v16, 0, v16
    v_cvt_pk_bf16_f32 v16, v16, v16
    v_lshlrev_b32 v16, 16, v16
    v_add_f32 v16, 0x3727c5ac, v16
    v_cvt_pk_bf16_f32 v16, v16, v16
    v_lshlrev_b32 v16, 16, v16
    v_sqrt_f32 v16, v16
    s_nop 0
    v_cvt_pk_bf16_f32 v16, v16, v16
    v_lshlrev_b32 v16, 16, v16
    v_mul_f32 v16, v16, v16
    v_rcp_f32 v16, v16
    v_cndmask_b32 v20, v20, v21, s[20:21]
    v_cndmask_b32 v20, v20, v22, s[22:23]
    v_cndmask_b32 v20, v20, v23, s[24:25]
    v_mul_f32 v36, 0x3acccccd, v36
    v_mul_f32 v20, 0x3acccccd, v20
    v_fma_f32 v20, -v36, v36, v20
    v_max_f32 v20, 0, v20
    v_cvt_pk_bf16_f32 v20, v20, v20
    v_lshlrev_b32 v20, 16, v20
    v_add_f32 v20, 0x3727c5ac, v20
    v_cvt_pk_bf16_f32 v20, v20, v20
    v_lshlrev_b32 v20, 16, v20
    v_sqrt_f32 v20, v20
    s_nop 0
    v_cvt_pk_bf16_f32 v20, v20, v20
    v_lshlrev_b32 v20, 16, v20
    v_mul_f32 v20, v20, v20
    v_rcp_f32 v20, v20
    v_cndmask_b32 v24, v24, v25, s[20:21]
    v_cndmask_b32 v24, v24, v26, s[22:23]
    v_cndmask_b32 v24, v24, v27, s[24:25]
    v_mul_f32 v40, 0x3acccccd, v40
    v_mul_f32 v24, 0x3acccccd, v24
    v_fma_f32 v24, -v40, v40, v24
    v_max_f32 v24, 0, v24
    v_cvt_pk_bf16_f32 v24, v24, v24
    v_lshlrev_b32 v24, 16, v24
    v_add_f32 v24, 0x3727c5ac, v24
    v_cvt_pk_bf16_f32 v24, v24, v24
    v_lshlrev_b32 v24, 16, v24
    v_sqrt_f32 v24, v24
    s_nop 0
    v_cvt_pk_bf16_f32 v24, v24, v24
    v_lshlrev_b32 v24, 16, v24
    v_mul_f32 v24, v24, v24
    v_rcp_f32 v24, v24
    v_cndmask_b32 v28, v28, v29, s[20:21]
    v_cndmask_b32 v28, v28, v30, s[22:23]
    v_cndmask_b32 v28, v28, v31, s[24:25]
    v_mul_f32 v44, 0x3acccccd, v44
    v_mul_f32 v28, 0x3acccccd, v28
    v_fma_f32 v28, -v44, v44, v28
    v_max_f32 v28, 0, v28
    v_cvt_pk_bf16_f32 v28, v28, v28
    v_lshlrev_b32 v28, 16, v28
    v_add_f32 v28, 0x3727c5ac, v28
    v_cvt_pk_bf16_f32 v28, v28, v28
    v_lshlrev_b32 v28, 16, v28
    v_sqrt_f32 v28, v28
    s_nop 0
    v_cvt_pk_bf16_f32 v28, v28, v28
    v_lshlrev_b32 v28, 16, v28
    v_mul_f32 v28, v28, v28
    v_rcp_f32 v28, v28
    s_mov_b64 exec, s[26:27]
    buffer_store_dword v16, v5, s[12:15], s28 offen offset:0 sc1
    buffer_store_dword v20, v5, s[12:15], s28 offen offset:64 sc1
    buffer_store_dword v24, v5, s[12:15], s28 offen offset:128 sc1
    buffer_store_dword v28, v5, s[12:15], s28 offen offset:192 sc1
    s_mov_b64 exec, -1
    s_branch K2_FIN
K_END:
    s_endpgm
CODE_END:
.section .rodata,"a"
.p2align 6
.amdhsa_kernel sequential_preLN__ssm_conv_s4__glu_gated_bilinear__prompt_kernel
  .amdhsa_next_free_vgpr 256
  .amdhsa_next_free_sgpr 96
  .amdhsa_accum_offset 256
  .amdhsa_group_segment_fixed_size 0
  .amdhsa_kernarg_size 128
  .amdhsa_user_sgpr_count 2
  .amdhsa_user_sgpr_kernarg_segment_ptr 1
  .amdhsa_system_sgpr_workgroup_id_x 1
.end_amdhsa_kernel
```
